```python
import torch

def _softmax(x, axis=-1):
    return torch.softmax(x, dim=axis)
def _gelu(x):
    return torch.nn.functional.gelu(x, approximate="tanh")
def _silu(x):
    return torch.nn.functional.silu(x)
def _sigmoid(x):
    return torch.sigmoid(x)
def _layernorm(x, axis=-1, eps=1e-5):
    m = x.mean(dim=axis, keepdim=True)
    v = x.var(dim=axis, keepdim=True, unbiased=False)
    return (x - m) / torch.sqrt(v + eps)
def _scatter_add(tgt, idx, src, axis=0):
    return tgt.clone().index_add_(axis, idx, src)
def _segment_sum(src, seg, n):
    out = torch.zeros((n,) + src.shape[1:], dtype=src.dtype)
    return out.index_add_(0, seg, src)
def _pad(x, pw):
    flat = tuple(v for pair in reversed(pw) for v in pair)
    return torch.nn.functional.pad(x, flat)

kernel_name = 'recurrent_scan__compressed_kv_cla__moe_arch_mod__decode'

def setup_inputs():

    _w = (lambda a: (lambda t: t.to(torch.bfloat16) if t.is_floating_point() else t)(torch.as_tensor(a)))
    def _A_setup():
        B, H, Sq, Sk, D, M = 4, 32, 1, 4096, 128, 512
        Dc = 4 * D
        return {
            "x": _w((lambda *s: torch.randn(*s, dtype=torch.bfloat16) * 0.05)(B, Sq, M)),
            "c_kv": _w((lambda *s: torch.randn(*s, dtype=torch.bfloat16) * 0.8)(B, Sk, Dc)),
            "w_q": _w((lambda *s: torch.randn(*s, dtype=torch.bfloat16) * 1.6)(M, H, D) * (M ** -0.5)),
            "w_uk": _w((lambda *s: torch.randn(*s, dtype=torch.bfloat16) * 1.6)(Dc, H, D) * (Dc ** -0.5)),
            "w_uv": _w((lambda *s: torch.randn(*s, dtype=torch.bfloat16) * 0.8)(Dc, H, D) * (Dc ** -0.5)),
            "w_o": _w((lambda *s: torch.randn(*s, dtype=torch.bfloat16) * 0.8)(H, D, M) * ((H * D) ** -0.5)),
        }
    _A_in = _A_setup()

    def _B_setup():
        B, S, D, F, C = 4, 1, 512, 1792, 1
        return {
            "x": _w((lambda *s: torch.randn(*s, dtype=torch.bfloat16) * 0.05)(B, S, D)),
            "w_r": _w((lambda *s: torch.randn(*s, dtype=torch.bfloat16) * 0.8)(D)),
            "w_gate": _w((lambda *s: torch.randn(*s, dtype=torch.bfloat16) * 0.2)(D, F)),
            "w_up": _w((lambda *s: torch.randn(*s, dtype=torch.bfloat16) * 0.2)(D, F)),
            "w_down": _w((lambda *s: torch.randn(*s, dtype=torch.bfloat16) * 0.2)(F, D)),
        }
    _B_in = _B_setup()

    return {
        "A_x": _A_in["x"],
        "A_c_kv": _A_in["c_kv"],
        "A_w_q": _A_in["w_q"],
        "A_w_uk": _A_in["w_uk"],
        "A_w_uv": _A_in["w_uv"],
        "A_w_o": _A_in["w_o"],
        "B_x": _B_in["x"],
        "B_w_r": _B_in["w_r"],
        "B_w_gate": _B_in["w_gate"],
        "B_w_up": _B_in["w_up"],
        "B_w_down": _B_in["w_down"],
    }

def reference(A_x, A_c_kv, A_w_q, A_w_uk, A_w_uv, A_w_o, B_x, B_w_r, B_w_gate, B_w_up, B_w_down):
    def _A_ref(x, c_kv, w_q, w_uk, w_uv, w_o):
        B, Sq, M = x.shape[0], x.shape[1], x.shape[2]
        Sk = c_kv.shape[1]
        H, D = w_q.shape[1], w_q.shape[2]
        q = torch.einsum("bqm,mhd->bhqd", x, w_q)
        k = torch.einsum("bkc,chd->bhkd", c_kv, w_uk)
        v = torch.einsum("bkc,chd->bhkd", c_kv, w_uv)
        scores = torch.einsum("bhqd,bhkd->bhqk", q, k) * (D ** -0.5)
        off = Sk - Sq
        qi = torch.arange(Sq)[:, None]
        kj = torch.arange(Sk)[None, :]
        cmask = kj <= (qi + off)
        scores = torch.where(cmask[None, None], scores, -1e9)
        p = _softmax(scores, axis=-1)
        ctx = torch.einsum("bhqk,bhkd->bhqd", p, v)
        return torch.einsum("bhqd,hdm->bqm", ctx, w_o)

    def _B_ref(x, w_r, w_gate, w_up, w_down):
        B, S, D = x.shape
        C = 1
        r = x @ w_r
        idx = torch.argsort(-r, axis=-1)[:, :C]
        idx_e = (lambda x, n, axis: torch.repeat_interleave(x, n, dim=axis))(idx.reshape(B, C, 1), D, axis=2)
        x_sel = (lambda x, i, axis: torch.take_along_dim(x, i, dim=axis))(x, idx_e, axis=1)
        g = _silu(x_sel @ w_gate)
        u = x_sel @ w_up
        y = (g * u) @ w_down
        r_sel = _sigmoid((lambda x, i, axis: torch.take_along_dim(x, i, dim=axis))(r, idx, axis=1))
        y = y * r_sel.reshape(B, C, 1)
        b_off = (torch.arange(B) * S).reshape(B, 1)
        flat_idx = (idx + b_off).reshape(B * C)
        zero = (x * 0.0).reshape(B * S, D)
        upd = _scatter_add(zero, flat_idx, y.reshape(B * C, D), axis=0)
        return x + upd.reshape(B, S, D)

    x = A_x
    xn = _layernorm(x, axis=-1)
    s = _A_ref(xn, A_c_kv, A_w_q, A_w_uk, A_w_uv, A_w_o)
    g = _silu(_B_ref(xn, B_w_r, B_w_gate, B_w_up, B_w_down))
    return x + s * g
```

```asm
; @launch kernel=k0_kernel grid=(256,1,1) block=(256,1,1) lds=36864
; @launch kernel=k1_kernel grid=(256,1,1) block=(512,1,1) lds=163840
.amdgcn_target "amdgcn-amd-amdhsa--gfx950"
.text
.globl k0_kernel
.p2align 8
.type k0_kernel,@function
k0_kernel:
    s_cmp_ge_u32 s2, 256
    s_cbranch_scc1 K0_done
    s_load_dwordx16 s[16:31], s[0:1], 0
    s_load_dwordx8 s[32:39], s[0:1], 64
    s_load_dwordx4 s[40:43], s[0:1], 96
    v_lshrrev_b32 v1, 6, v0
    v_and_b32 v0, 0xff, v0
    v_readfirstlane_b32 s3, v1
    v_and_b32 v1, 63, v0
    v_lshrrev_b32 v2, 4, v1
    v_and_b32 v3, 15, v1
    v_lshrrev_b32 v40, 2, v3
    v_and_b32 v41, 3, v3
    v_lshlrev_b32 v4, 4, v1
    s_and_b32 s68, s2, 7
    s_lshl_b32 s68, s68, 2
    s_lshr_b32 s4, s2, 3
    s_and_b32 s4, s4, 3
    s_add_u32 s68, s68, s4
    s_lshr_b32 s69, s2, 5
    s_mov_b32 s4, 0x12492493
    s_mul_hi_u32 s71, s2, s4
    s_mul_i32 s4, s71, 14
    s_sub_u32 s70, s2, s4
    s_waitcnt lgkmcnt(0)
    s_mov_b32 s64, s42
    s_and_b32 s65, s43, 0xffff
    s_mov_b32 s66, 0x1000000
    s_mov_b32 s67, 0x00020000
    s_mov_b32 s44, s20
    s_and_b32 s45, s21, 0xffff
    s_mov_b32 s46, 0x400000
    s_mov_b32 s47, 0x00020000
    s_mov_b32 s48, s32
    s_and_b32 s49, s33, 0xffff
    s_mov_b32 s50, 0x1c0000
    s_mov_b32 s51, 0x00020000
    s_mov_b32 s52, s34
    s_and_b32 s53, s35, 0xffff
    s_mov_b32 s54, 0x1c0000
    s_mov_b32 s55, 0x00020000
    s_mov_b32 s56, s16
    s_and_b32 s57, s17, 0xffff
    s_mov_b32 s58, 0x1000
    s_mov_b32 s59, 0x00020000
    s_lshl_b32 s4, s3, 10
    buffer_load_dwordx4 v[8:11], v4, s[56:59], s4 offen
    s_and_b32 s5, s3, 1
    s_lshl_b32 s5, s5, 3
    v_lshlrev_b32 v5, 1, v2
    v_add_u32 v5, s5, v5
    v_xor_b32 v5, v5, v3
    v_lshlrev_b32 v5, 4, v5
    v_lshl_add_u32 v6, v2, 13, v5
    s_lshl_b32 s6, s68, 8
    s_lshl_b32 s7, s69, 19
    s_add_u32 s6, s6, s7
    s_lshl_b32 s7, s3, 15
    s_add_u32 s6, s6, s7
    s_lshl_b32 s8, s3, 10
    s_mov_b32 m0, s8
    s_add_u32 s8, s8, 4096
    buffer_load_dwordx4 v6, s[44:47], s6 offen lds
    s_add_u32 s6, s6, 131072
    s_mov_b32 m0, s8
    s_add_u32 s8, s8, 4096
    buffer_load_dwordx4 v6, s[44:47], s6 offen lds
    s_add_u32 s6, s6, 131072
    s_mov_b32 m0, s8
    s_add_u32 s8, s8, 4096
    buffer_load_dwordx4 v6, s[44:47], s6 offen lds
    s_add_u32 s6, s6, 131072
    s_mov_b32 m0, s8
    s_add_u32 s8, s8, 4096
    buffer_load_dwordx4 v6, s[44:47], s6 offen lds
    s_add_u32 s6, s6, 131072
    s_cmp_ge_u32 s2, 224
    s_cbranch_scc1 K0_noffn
    s_mov_b32 s8, 3584
    v_mul_lo_u32 v12, v2, s8
    v_add_u32 v12, v12, v5
    s_lshl_b32 s7, s70, 8
    s_lshl_b32 s9, s71, 5
    s_lshl_b32 s10, s3, 2
    s_add_u32 s9, s9, s10
    s_mul_i32 s9, s9, 3584
    s_add_u32 s7, s7, s9
    s_lshl_b32 s8, s3, 10
    s_add_u32 s8, s8, 16384
    s_add_u32 s10, s8, 0
    s_mov_b32 m0, s10
    s_add_u32 s9, s7, 0
    buffer_load_dwordx4 v12, s[48:51], s9 offen lds
    s_add_u32 s10, s8, 4096
    s_mov_b32 m0, s10
    s_add_u32 s9, s7, 57344
    buffer_load_dwordx4 v12, s[48:51], s9 offen lds
    s_add_u32 s10, s8, 8192
    s_mov_b32 m0, s10
    s_add_u32 s9, s7, 0
    buffer_load_dwordx4 v12, s[52:55], s9 offen lds
    s_add_u32 s10, s8, 12288
    s_mov_b32 m0, s10
    s_add_u32 s9, s7, 57344
    buffer_load_dwordx4 v12, s[52:55], s9 offen lds
K0_noffn:
    s_waitcnt vmcnt(4)
    v_lshlrev_b32 v20, 16, v8
    v_and_b32 v21, 0xffff0000, v8
    v_lshlrev_b32 v22, 16, v9
    v_and_b32 v23, 0xffff0000, v9
    v_lshlrev_b32 v24, 16, v10
    v_and_b32 v25, 0xffff0000, v10
    v_lshlrev_b32 v26, 16, v11
    v_and_b32 v27, 0xffff0000, v11
    v_add_f32 v28, v20, v21
    v_add_f32 v28, v28, v22
    v_add_f32 v28, v28, v23
    v_add_f32 v28, v28, v24
    v_add_f32 v28, v28, v25
    v_add_f32 v28, v28, v26
    v_add_f32 v28, v28, v27
    s_nop 1
    v_add_f32_dpp v28, v28, v28 row_shr:1 row_mask:0xf bank_mask:0xf
    s_nop 1
    v_add_f32_dpp v28, v28, v28 row_shr:2 row_mask:0xf bank_mask:0xf
    s_nop 1
    v_add_f32_dpp v28, v28, v28 row_shr:4 row_mask:0xf bank_mask:0xf
    s_nop 1
    v_add_f32_dpp v28, v28, v28 row_shr:8 row_mask:0xf bank_mask:0xf
    s_nop 1
    v_add_f32_dpp v28, v28, v28 row_bcast:15 row_mask:0xa bank_mask:0xf
    s_nop 1
    v_add_f32_dpp v28, v28, v28 row_bcast:31 row_mask:0xc bank_mask:0xf
    s_nop 1
    v_readlane_b32 s72, v28, 63
    s_nop 3
    v_mov_b32 v29, s72
    v_mul_f32 v29, 0x3b000000, v29
    v_sub_f32 v30, v20, v29
    v_mul_f32 v28, v30, v30
    v_sub_f32 v30, v21, v29
    v_fmac_f32 v28, v30, v30
    v_sub_f32 v30, v22, v29
    v_fmac_f32 v28, v30, v30
    v_sub_f32 v30, v23, v29
    v_fmac_f32 v28, v30, v30
    v_sub_f32 v30, v24, v29
    v_fmac_f32 v28, v30, v30
    v_sub_f32 v30, v25, v29
    v_fmac_f32 v28, v30, v30
    v_sub_f32 v30, v26, v29
    v_fmac_f32 v28, v30, v30
    v_sub_f32 v30, v27, v29
    v_fmac_f32 v28, v30, v30
    s_nop 1
    v_add_f32_dpp v28, v28, v28 row_shr:1 row_mask:0xf bank_mask:0xf
    s_nop 1
    v_add_f32_dpp v28, v28, v28 row_shr:2 row_mask:0xf bank_mask:0xf
    s_nop 1
    v_add_f32_dpp v28, v28, v28 row_shr:4 row_mask:0xf bank_mask:0xf
    s_nop 1
    v_add_f32_dpp v28, v28, v28 row_shr:8 row_mask:0xf bank_mask:0xf
    s_nop 1
    v_add_f32_dpp v28, v28, v28 row_bcast:15 row_mask:0xa bank_mask:0xf
    s_nop 1
    v_add_f32_dpp v28, v28, v28 row_bcast:31 row_mask:0xc bank_mask:0xf
    s_nop 1
    v_readlane_b32 s72, v28, 63
    s_nop 3
    v_mov_b32 v30, s72
    v_mul_f32 v30, 0x3b000000, v30
    v_cvt_pk_bf16_f32 v31, v29, v29
    v_lshlrev_b32 v29, 16, v31
    v_cvt_pk_bf16_f32 v31, v30, v30
    v_lshlrev_b32 v30, 16, v31
    v_add_f32 v30, 0x3727c5ac, v30
    v_cvt_pk_bf16_f32 v31, v30, v30
    v_lshlrev_b32 v30, 16, v31
    v_sqrt_f32 v30, v30
    s_nop 0
    v_cvt_pk_bf16_f32 v31, v30, v30
    v_lshlrev_b32 v30, 16, v31
    v_rcp_f32 v31, v30
    s_nop 0
    v_sub_f32 v20, v20, v29
    v_cvt_pk_bf16_f32 v32, v20, v20
    v_lshlrev_b32 v20, 16, v32
    v_mul_f32 v32, v20, v31
    v_fma_f32 v33, -v32, v30, v20
    v_fma_f32 v20, v33, v31, v32
    v_cvt_pk_bf16_f32 v32, v20, v20
    v_lshlrev_b32 v20, 16, v32
    v_sub_f32 v21, v21, v29
    v_cvt_pk_bf16_f32 v32, v21, v21
    v_lshlrev_b32 v21, 16, v32
    v_mul_f32 v32, v21, v31
    v_fma_f32 v33, -v32, v30, v21
    v_fma_f32 v21, v33, v31, v32
    v_cvt_pk_bf16_f32 v32, v21, v21
    v_lshlrev_b32 v21, 16, v32
    v_sub_f32 v22, v22, v29
    v_cvt_pk_bf16_f32 v32, v22, v22
    v_lshlrev_b32 v22, 16, v32
    v_mul_f32 v32, v22, v31
    v_fma_f32 v33, -v32, v30, v22
    v_fma_f32 v22, v33, v31, v32
    v_cvt_pk_bf16_f32 v32, v22, v22
    v_lshlrev_b32 v22, 16, v32
    v_sub_f32 v23, v23, v29
    v_cvt_pk_bf16_f32 v32, v23, v23
    v_lshlrev_b32 v23, 16, v32
    v_mul_f32 v32, v23, v31
    v_fma_f32 v33, -v32, v30, v23
    v_fma_f32 v23, v33, v31, v32
    v_cvt_pk_bf16_f32 v32, v23, v23
    v_lshlrev_b32 v23, 16, v32
    v_sub_f32 v24, v24, v29
    v_cvt_pk_bf16_f32 v32, v24, v24
    v_lshlrev_b32 v24, 16, v32
    v_mul_f32 v32, v24, v31
    v_fma_f32 v33, -v32, v30, v24
    v_fma_f32 v24, v33, v31, v32
    v_cvt_pk_bf16_f32 v32, v24, v24
    v_lshlrev_b32 v24, 16, v32
    v_sub_f32 v25, v25, v29
    v_cvt_pk_bf16_f32 v32, v25, v25
    v_lshlrev_b32 v25, 16, v32
    v_mul_f32 v32, v25, v31
    v_fma_f32 v33, -v32, v30, v25
    v_fma_f32 v25, v33, v31, v32
    v_cvt_pk_bf16_f32 v32, v25, v25
    v_lshlrev_b32 v25, 16, v32
    v_sub_f32 v26, v26, v29
    v_cvt_pk_bf16_f32 v32, v26, v26
    v_lshlrev_b32 v26, 16, v32
    v_mul_f32 v32, v26, v31
    v_fma_f32 v33, -v32, v30, v26
    v_fma_f32 v26, v33, v31, v32
    v_cvt_pk_bf16_f32 v32, v26, v26
    v_lshlrev_b32 v26, 16, v32
    v_sub_f32 v27, v27, v29
    v_cvt_pk_bf16_f32 v32, v27, v27
    v_lshlrev_b32 v27, 16, v32
    v_mul_f32 v32, v27, v31
    v_fma_f32 v33, -v32, v30, v27
    v_fma_f32 v27, v33, v31, v32
    v_cvt_pk_bf16_f32 v32, v27, v27
    v_lshlrev_b32 v27, 16, v32
    v_cvt_pk_bf16_f32 v36, v20, v21
    v_cvt_pk_bf16_f32 v37, v22, v23
    v_cvt_pk_bf16_f32 v38, v24, v25
    v_cvt_pk_bf16_f32 v39, v26, v27
    v_lshrrev_b32 v14, 2, v1
    v_lshlrev_b32 v14, 6, v14
    v_and_b32 v15, 1, v1
    v_lshl_add_u32 v14, v15, 5, v14
    v_bfe_u32 v15, v1, 1, 1
    v_lshl_add_u32 v14, v15, 3, v14
    s_lshl_b32 s4, s3, 10
    s_add_u32 s4, s4, 32768
    v_add_u32 v14, s4, v14
    ds_write_b64 v14, v[36:37]
    ds_write_b64 v14, v[38:39] offset:16
    s_cmp_lg_u32 s2, 0
    s_cbranch_scc1 K0_noxn
    s_lshl_b32 s4, s3, 10
    buffer_store_dwordx4 v[36:39], v4, s[64:67], s4 offen
K0_noxn:
    v_and_b32 v42, 1, v2
    v_lshl_add_u32 v42, v42, 2, v40
    v_lshl_add_u32 v43, v2, 2, v40
    v_lshlrev_b32 v43, 8, v43
    v_lshl_add_u32 v43, v41, 3, v43
    s_lshl_b32 s4, s3, 1
    v_xor_b32 v44, s4, v42
    v_lshl_add_u32 v44, v44, 5, v43
    s_add_u32 s4, s4, 1
    v_xor_b32 v45, s4, v42
    v_lshl_add_u32 v45, v45, 5, v43
    v_lshlrev_b32 v48, 10, v41
    v_lshl_add_u32 v48, v2, 4, v48
    v_add_u32 v48, 32768, v48
    s_waitcnt vmcnt(0) lgkmcnt(0)
    s_barrier
    v_mov_b32 v16, -1
    v_mov_b32 v17, -1
    v_mov_b32 v18, -1
    v_mov_b32 v19, -1
    v_lshlrev_b32 v13, 4, v0
    s_lshl_b32 s7, s2, 15
    s_add_u32 s7, s7, 2097152
    s_cmp_lg_u32 s3, 0
    s_cbranch_scc1 K0_noml
    v_mov_b32 v20, 0
    v_mov_b32 v21, 0
    v_mov_b32 v22, 0
    v_mov_b32 v23, 0
    s_mov_b64 exec, 0xffffffff
    s_lshl_b32 s7, s2, 9
    s_add_u32 s8, s7, 10485760
    buffer_store_dwordx4 v[16:19], v13, s[64:67], s8 offen
    s_add_u32 s8, s7, 65536
    buffer_store_dwordx4 v[16:19], v13, s[64:67], s8 offen
    s_add_u32 s8, s7, 10616832
    buffer_store_dwordx4 v[20:23], v13, s[64:67], s8 offen
    s_add_u32 s8, s7, 10747904
    buffer_store_dwordx4 v[20:23], v13, s[64:67], s8 offen
    s_mov_b64 exec, -1
K0_noml:
    s_lshl_b32 s4, s69, 7
    v_add_u32 v52, s4, v48
    ds_read_b128 v[96:99], v52
    ds_read_b128 v[100:103], v52 offset:64
    ds_read_b64_tr_b16 v[104:105], v44 offset:0
    ds_read_b64_tr_b16 v[106:107], v44 offset:4096
    ds_read_b64_tr_b16 v[108:109], v44 offset:8192
    ds_read_b64_tr_b16 v[110:111], v44 offset:12288
    ds_read_b64_tr_b16 v[112:113], v45 offset:0
    ds_read_b64_tr_b16 v[114:115], v45 offset:4096
    ds_read_b64_tr_b16 v[116:117], v45 offset:8192
    ds_read_b64_tr_b16 v[118:119], v45 offset:12288
    s_waitcnt lgkmcnt(0)
    v_mfma_f32_16x16x32_bf16 v[80:83], v[104:107], v[96:99], 0
    v_mfma_f32_16x16x32_bf16 v[80:83], v[108:111], v[100:103], v[80:83]
    v_mfma_f32_16x16x32_bf16 v[84:87], v[112:115], v[96:99], 0
    v_mfma_f32_16x16x32_bf16 v[84:87], v[116:119], v[100:103], v[84:87]
    v_lshlrev_b32 v51, 9, v41
    v_lshl_add_u32 v51, v2, 4, v51
    s_lshl_b32 s4, s68, 14
    s_lshl_b32 s5, s69, 11
    s_add_u32 s4, s4, s5
    s_lshl_b32 s5, s3, 7
    s_add_u32 s4, s4, s5
    s_add_u32 s4, s4, 1310720
    s_nop 7
    v_cmp_gt_u32 vcc, 4, v3
    s_and_saveexec_b64 s[10:11], vcc
    buffer_store_dwordx4 v[80:83], v51, s[64:67], s4 offen offset:0
    buffer_store_dwordx4 v[84:87], v51, s[64:67], s4 offen offset:64
    s_mov_b64 exec, s[10:11]
    s_cmp_ge_u32 s2, 224
    s_cbranch_scc1 K0_done
    s_lshl_b32 s4, s71, 6
    v_add_u32 v52, s4, v48
    ds_read_b128 v[96:99], v52
    ds_read_b64_tr_b16 v[100:101], v44 offset:16384
    ds_read_b64_tr_b16 v[102:103], v44 offset:20480
    ds_read_b64_tr_b16 v[104:105], v45 offset:16384
    ds_read_b64_tr_b16 v[106:107], v45 offset:20480
    ds_read_b64_tr_b16 v[108:109], v44 offset:24576
    ds_read_b64_tr_b16 v[110:111], v44 offset:28672
    ds_read_b64_tr_b16 v[112:113], v45 offset:24576
    ds_read_b64_tr_b16 v[114:115], v45 offset:28672
    s_waitcnt lgkmcnt(0)
    v_mfma_f32_16x16x32_bf16 v[120:123], v[100:103], v[96:99], 0
    v_mfma_f32_16x16x32_bf16 v[124:127], v[104:107], v[96:99], 0
    v_mfma_f32_16x16x32_bf16 v[128:131], v[108:111], v[96:99], 0
    v_mfma_f32_16x16x32_bf16 v[132:135], v[112:115], v[96:99], 0
    s_mov_b32 s4, 7168
    v_mul_lo_u32 v54, v41, s4
    v_lshl_add_u32 v54, v2, 4, v54
    s_mul_i32 s4, s71, 57344
    s_lshl_b32 s5, s70, 9
    s_add_u32 s4, s4, s5
    s_lshl_b32 s5, s3, 7
    s_add_u32 s4, s4, s5
    s_add_u32 s4, s4, 262144
    s_nop 7
    v_cmp_gt_u32 vcc, 4, v3
    s_and_saveexec_b64 s[10:11], vcc
    s_add_u32 s5, s4, 0
    buffer_store_dwordx4 v[120:123], v54, s[64:67], s5 offen offset:0
    buffer_store_dwordx4 v[124:127], v54, s[64:67], s5 offen offset:64
    s_add_u32 s5, s4, 28672
    buffer_store_dwordx4 v[128:131], v54, s[64:67], s5 offen offset:0
    buffer_store_dwordx4 v[132:135], v54, s[64:67], s5 offen offset:64
    s_mov_b64 exec, s[10:11]
K0_done:
    s_endpgm
.globl k1_kernel
.p2align 8
.type k1_kernel,@function
k1_kernel:
    s_cmp_ge_u32 s2, 256
    s_cbranch_scc1 L_done
    s_load_dwordx16 s[16:31], s[0:1], 0
    s_load_dwordx8 s[32:39], s[0:1], 64
    s_load_dwordx4 s[40:43], s[0:1], 96
    v_lshrrev_b32 v1, 6, v0
    v_and_b32 v0, 0xff, v0
    v_readfirstlane_b32 s77, v1
    v_and_b32 v1, 63, v0
    v_lshrrev_b32 v2, 4, v1
    v_and_b32 v3, 15, v1
    v_lshrrev_b32 v40, 2, v3
    v_and_b32 v41, 3, v3
    v_lshlrev_b32 v4, 4, v1
    v_mov_b32 v250, 153344
    v_mov_b32 v251, 1
    v_lshlrev_b32 v252, 2, v1
    v_add_u32 v252, 153344, v252
    v_mov_b32 v253, 0
    ds_write_b32 v252, v253
    s_and_b32 s3, s77, 3
    s_lshr_b32 s77, s77, 2
    s_and_b32 s68, s2, 7
    s_lshl_b32 s68, s68, 2
    s_lshr_b32 s4, s2, 3
    s_and_b32 s4, s4, 3
    s_add_u32 s68, s68, s4
    s_lshr_b32 s69, s2, 5
    s_lshr_b32 s74, s2, 3
    s_and_b32 s74, s74, 1
    s_and_b32 s4, s2, 7
    s_lshr_b32 s5, s2, 4
    s_lshl_b32 s5, s5, 3
    s_or_b32 s4, s4, s5
    s_lshr_b32 s75, s4, 5
    s_and_b32 s76, s4, 31
    s_waitcnt lgkmcnt(0)
    s_barrier
    s_mov_b32 s64, s42
    s_and_b32 s65, s43, 0xffff
    s_mov_b32 s66, 0x1000000
    s_mov_b32 s67, 0x00020000
    s_cmp_eq_u32 s77, 0
    s_cbranch_scc0 L_loader
    s_mov_b32 s48, s22
    s_and_b32 s49, s23, 0xffff
    s_mov_b32 s50, 0x400000
    s_mov_b32 s51, 0x00020000
    s_mov_b32 s52, s16
    s_and_b32 s53, s17, 0xffff
    s_mov_b32 s54, 0x1000
    s_mov_b32 s55, 0x00020000
    v_lshlrev_b32 v5, 3, v1
    s_lshl_b32 s4, s68, 14
    s_lshl_b32 s5, s3, 9
    s_add_u32 s4, s4, s5
    s_add_u32 s4, s4, 1310720
    buffer_load_dwordx2 v[96:97], v5, s[64:67], s4 offen offset:0
    buffer_load_dwordx2 v[98:99], v5, s[64:67], s4 offen offset:2048
    s_add_u32 s5, s4, 4096
    buffer_load_dwordx2 v[100:101], v5, s[64:67], s5 offen offset:0
    buffer_load_dwordx2 v[102:103], v5, s[64:67], s5 offen offset:2048
    s_add_u32 s5, s4, 8192
    buffer_load_dwordx2 v[104:105], v5, s[64:67], s5 offen offset:0
    buffer_load_dwordx2 v[106:107], v5, s[64:67], s5 offen offset:2048
    s_add_u32 s5, s4, 12288
    buffer_load_dwordx2 v[108:109], v5, s[64:67], s5 offen offset:0
    buffer_load_dwordx2 v[110:111], v5, s[64:67], s5 offen offset:2048
    s_add_u32 s5, s4, 16384
    s_lshl_b32 s6, s68, 8
    s_lshl_b32 s7, s69, 6
    s_lshl_b32 s8, s3, 4
    s_add_u32 s7, s7, s8
    v_add_u32 v7, s7, v3
    v_lshlrev_b32 v7, 13, v7
    v_lshl_add_u32 v7, v2, 4, v7
    v_add_u32 v7, s6, v7
    buffer_load_dwordx4 v[64:67], v7, s[48:51], 0 offen offset:0
    buffer_load_dwordx4 v[68:71], v7, s[48:51], 0 offen offset:64
    buffer_load_dwordx4 v[72:75], v7, s[48:51], 0 offen offset:128
    buffer_load_dwordx4 v[76:79], v7, s[48:51], 0 offen offset:192
    s_mov_b32 s56, s36
    s_and_b32 s57, s37, 0xffff
    s_mov_b32 s58, 0x1c0000
    s_mov_b32 s59, 0x00020000
    s_lshl_b32 s4, s2, 3
    s_lshl_b32 s5, s3, 1
    s_add_u32 s4, s4, s5
    s_lshl_b32 s4, s4, 10
    s_lshl_b32 s5, s3, 11
    s_add_u32 s5, s5, 135168
    s_mov_b32 m0, s5
    s_add_u32 s5, s5, 1024
    buffer_load_dwordx4 v4, s[56:59], s4 offen lds
    s_add_u32 s4, s4, 1024
    s_mov_b32 m0, s5
    s_add_u32 s5, s5, 1024
    buffer_load_dwordx4 v4, s[56:59], s4 offen lds
    s_add_u32 s4, s4, 1024
    v_and_b32 v42, 1, v2
    v_lshl_add_u32 v42, v42, 2, v40
    v_lshl_add_u32 v43, v2, 2, v40
    v_lshlrev_b32 v43, 8, v43
    v_lshl_add_u32 v43, v41, 3, v43
    s_lshl_b32 s4, s3, 8
    s_add_u32 s4, s4, 155648
    v_lshlrev_b32 v49, 2, v1
    v_add_u32 v49, s4, v49
    v_lshlrev_b32 v50, 8, v41
    v_lshl_add_u32 v50, v2, 4, v50
    v_add_u32 v50, 155648, v50
    s_waitcnt vmcnt(6)
    v_add_f32 v96, v96, v98
    v_add_f32 v97, v97, v99
    v_add_f32 v96, v96, v100
    v_add_f32 v97, v97, v101
    v_add_f32 v96, v96, v102
    v_add_f32 v97, v97, v103
    v_add_f32 v96, v96, v104
    v_add_f32 v97, v97, v105
    v_add_f32 v96, v96, v106
    v_add_f32 v97, v97, v107
    v_add_f32 v96, v96, v108
    v_add_f32 v97, v97, v109
    v_add_f32 v96, v96, v110
    v_add_f32 v97, v97, v111
    v_cvt_pk_bf16_f32 v88, v96, v97
    ds_write_b32 v49, v88
    s_waitcnt lgkmcnt(0)
    s_mov_b64 exec, 1
    ds_add_u32 v250, v251 offset:0
    s_mov_b64 exec, -1
LW1:
    ds_read_b32 v252, v250 offset:0
    s_waitcnt lgkmcnt(0)
    v_readfirstlane_b32 s79, v252
    s_cmp_lt_u32 s79, 4
    s_cbranch_scc1 LW1
    ds_read_b128 v[96:99], v50 offset:0
    ds_read_b128 v[100:103], v50 offset:64
    ds_read_b128 v[104:107], v50 offset:128
    ds_read_b128 v[108:111], v50 offset:192
    s_waitcnt vmcnt(0) lgkmcnt(0)
    v_mfma_f32_16x16x32_bf16 v[80:83], v[64:67], v[96:99], 0
    v_mfma_f32_16x16x32_bf16 v[80:83], v[68:71], v[100:103], v[80:83]
    v_mfma_f32_16x16x32_bf16 v[80:83], v[72:75], v[104:107], v[80:83]
    v_mfma_f32_16x16x32_bf16 v[80:83], v[76:79], v[108:111], v[80:83]
    v_lshlrev_b32 v51, 15, v41
    v_lshl_add_u32 v51, v2, 3, v51
    s_lshl_b32 s4, s68, 10
    s_lshl_b32 s5, s69, 7
    s_add_u32 s4, s4, s5
    s_lshl_b32 s5, s3, 5
    s_add_u32 s4, s4, s5
    s_add_u32 s4, s4, 65536
    s_nop 7
    v_cvt_pk_bf16_f32 v88, v80, v81
    v_cvt_pk_bf16_f32 v89, v82, v83
    v_cmp_gt_u32 vcc, 4, v3
    s_and_saveexec_b64 s[10:11], vcc
    buffer_store_dwordx2 v[88:89], v51, s[64:67], s4 offen sc1
    s_mov_b64 exec, s[10:11]
    s_cmp_ge_u32 s2, 224
    s_cbranch_scc1 LC_nf1
    v_and_b32 v7, 7, v1
    v_lshlrev_b32 v7, 2, v7
    v_lshrrev_b32 v30, 3, v1
    s_mov_b32 s4, 7168
    v_mul_lo_u32 v30, v30, s4
    v_add_u32 v7, v7, v30
    s_mul_i32 s4, s3, 229376
    s_lshl_b32 s5, s2, 5
    s_add_u32 s4, s4, s5
    s_add_u32 s4, s4, 262144
    buffer_load_dword v232, v7, s[64:67], s4 offen
    s_add_u32 s4, s4, 57344
    buffer_load_dword v233, v7, s[64:67], s4 offen
    s_add_u32 s4, s4, 57344
    buffer_load_dword v234, v7, s[64:67], s4 offen
    s_add_u32 s4, s4, 57344
    buffer_load_dword v235, v7, s[64:67], s4 offen
    s_add_u32 s4, s4, 57344
LC_nf1:
    s_mov_b32 s48, s30
    s_and_b32 s49, s31, 0xffff
    s_mov_b32 s50, 0x400
    s_mov_b32 s51, 0x00020000
    s_lshr_b32 s4, s2, 6
    s_lshl_b32 s4, s4, 10
    buffer_load_dwordx4 v[236:239], v4, s[64:67], s4 offen
    buffer_load_dwordx4 v[240:243], v4, s[48:51], 0 offen
    v_and_b32 v246, 7, v1
    v_lshlrev_b32 v246, 1, v246
    s_and_b32 s5, s2, 63
    s_lshl_b32 s5, s5, 4
    s_add_u32 s78, s5, s4
    buffer_load_ushort v244, v246, s[52:55], s78 offen
    buffer_load_ushort v245, v246, s[64:67], s78 offen
    s_waitcnt vmcnt(4)
    s_cmp_ge_u32 s2, 224
    s_cbranch_scc1 LC_nf2
    v_add_f32 v232, v232, v233
    v_add_f32 v234, v234, v235
    v_add_f32 v232, v232, v234
    v_lshlrev_b32 v22, 2, v0
    v_add_u32 v22, 152064, v22
    ds_write_b32 v22, v232
LC_nf2:
    s_waitcnt lgkmcnt(0)
    s_mov_b64 exec, 1
    ds_add_u32 v250, v251 offset:28
    s_mov_b64 exec, -1
LW2:
    ds_read_b32 v252, v250 offset:28
    s_waitcnt lgkmcnt(0)
    v_readfirstlane_b32 s79, v252
    s_cmp_lt_u32 s79, 4
    s_cbranch_scc1 LW2
    v_lshlrev_b32 v36, 11, v41
    v_lshl_add_u32 v36, v2, 4, v36
    s_cmp_ge_u32 s2, 224
    s_cbranch_scc1 LC_nf3
    s_lshl_b32 s7, s2, 13
    s_lshl_b32 s5, s3, 9
    s_add_u32 s7, s7, s5
    s_add_u32 s7, s7, 8388608
    v_and_b32 v22, 31, v1
    v_lshlrev_b32 v22, 2, v22
    v_add_u32 v22, 152064, v22
    ds_read_b32 v24, v22 offset:0
    ds_read_b32 v28, v22 offset:128
    ds_read_b32 v25, v22 offset:256
    ds_read_b32 v29, v22 offset:384
    ds_read_b32 v26, v22 offset:512
    ds_read_b32 v30, v22 offset:640
    ds_read_b32 v27, v22 offset:768
    ds_read_b32 v31, v22 offset:896
    v_lshlrev_b32 v23, 10, v42
    v_lshl_add_u32 v23, v41, 3, v23
    s_lshl_b32 s4, s3, 8
    s_add_u32 s4, s4, 135168
    v_add_u32 v23, s4, v23
    ds_read_b64_tr_b16 v[128:129], v23 offset:0
    ds_read_b64_tr_b16 v[132:133], v23 offset:32
    ds_read_b64_tr_b16 v[136:137], v23 offset:64
    ds_read_b64_tr_b16 v[140:141], v23 offset:96
    ds_read_b64_tr_b16 v[144:145], v23 offset:128
    ds_read_b64_tr_b16 v[148:149], v23 offset:160
    ds_read_b64_tr_b16 v[152:153], v23 offset:192
    ds_read_b64_tr_b16 v[156:157], v23 offset:224
    s_waitcnt lgkmcnt(8)
    v_add_f32 v24, v24, v25
    v_add_f32 v26, v26, v27
    v_add_f32 v24, v24, v26
    v_add_f32 v28, v28, v29
    v_add_f32 v30, v30, v31
    v_add_f32 v28, v28, v30
    v_cvt_pk_bf16_f32 v25, v24, v24
    v_lshlrev_b32 v24, 16, v25
    v_cvt_pk_bf16_f32 v25, v28, v28
    v_lshlrev_b32 v28, 16, v25
    v_mul_f32 v25, 0xbfb8aa3b, v24
    v_exp_f32 v25, v25
    s_nop 0
    v_add_f32 v25, 1.0, v25
    v_rcp_f32 v25, v25
    s_nop 0
    v_mul_f32 v24, v24, v25
    v_cvt_pk_bf16_f32 v25, v24, v24
    v_lshlrev_b32 v24, 16, v25
    v_mul_f32 v24, v24, v28
    v_cvt_pk_bf16_f32 v24, v24, v24
    v_and_b32 v22, 31, v1
    v_lshlrev_b32 v22, 1, v22
    s_lshl_b32 s4, s3, 6
    s_add_u32 s4, s4, 153088
    v_add_u32 v22, s4, v22
    ds_write_b16 v22, v24
    v_lshlrev_b32 v22, 4, v41
    v_and_b32 v23, 1, v2
    v_lshl_add_u32 v22, v23, 3, v22
    v_add_u32 v22, s4, v22
    s_waitcnt lgkmcnt(0)
    ds_read_b64 v[32:33], v22
    v_mov_b32 v34, 0
    v_mov_b32 v35, 0
    v_mov_b32 v130, v128
    v_mov_b32 v131, v129
    v_mov_b32 v134, v132
    v_mov_b32 v135, v133
    v_mov_b32 v138, v136
    v_mov_b32 v139, v137
    v_mov_b32 v142, v140
    v_mov_b32 v143, v141
    v_mov_b32 v146, v144
    v_mov_b32 v147, v145
    v_mov_b32 v150, v148
    v_mov_b32 v151, v149
    v_mov_b32 v154, v152
    v_mov_b32 v155, v153
    v_mov_b32 v158, v156
    v_mov_b32 v159, v157
    v_cmp_gt_u32 vcc, 2, v2
    s_waitcnt lgkmcnt(0)
    v_cndmask_b32 v32, 0, v32, vcc
    v_cndmask_b32 v33, 0, v33, vcc
    s_nop 1
    v_mfma_f32_16x16x32_bf16 v[160:163], v[128:131], v[32:35], 0
    v_mfma_f32_16x16x32_bf16 v[164:167], v[132:135], v[32:35], 0
    v_mfma_f32_16x16x32_bf16 v[168:171], v[136:139], v[32:35], 0
    v_mfma_f32_16x16x32_bf16 v[172:175], v[140:143], v[32:35], 0
    v_mfma_f32_16x16x32_bf16 v[176:179], v[144:147], v[32:35], 0
    v_mfma_f32_16x16x32_bf16 v[180:183], v[148:151], v[32:35], 0
    v_mfma_f32_16x16x32_bf16 v[184:187], v[152:155], v[32:35], 0
    v_mfma_f32_16x16x32_bf16 v[188:191], v[156:159], v[32:35], 0
    s_nop 7
    v_cmp_gt_u32 vcc, 4, v3
    s_and_saveexec_b64 s[10:11], vcc
    buffer_store_dwordx4 v[160:163], v36, s[64:67], s7 offen offset:0 sc1
    buffer_store_dwordx4 v[164:167], v36, s[64:67], s7 offen offset:64 sc1
    buffer_store_dwordx4 v[168:171], v36, s[64:67], s7 offen offset:128 sc1
    buffer_store_dwordx4 v[172:175], v36, s[64:67], s7 offen offset:192 sc1
    buffer_store_dwordx4 v[176:179], v36, s[64:67], s7 offen offset:256 sc1
    buffer_store_dwordx4 v[180:183], v36, s[64:67], s7 offen offset:320 sc1
    buffer_store_dwordx4 v[184:187], v36, s[64:67], s7 offen offset:384 sc1
    buffer_store_dwordx4 v[188:191], v36, s[64:67], s7 offen offset:448 sc1
    s_mov_b64 exec, s[10:11]
LC_nf3:
    s_mov_b64 exec, 1
    ds_add_u32 v250, v251 offset:68
    s_mov_b64 exec, -1
    s_lshl_b32 s6, s3, 2
    s_add_u32 s7, s6, 0
    v_xor_b32 v24, s7, v1
    v_lshlrev_b32 v24, 4, v24
    s_lshl_b32 s7, s7, 10
    s_add_u32 s7, s7, 135168
    v_add_u32 v24, s7, v24
    s_add_u32 s7, s6, 1
    v_xor_b32 v25, s7, v1
    v_lshlrev_b32 v25, 4, v25
    s_lshl_b32 s7, s7, 10
    s_add_u32 s7, s7, 135168
    v_add_u32 v25, s7, v25
    s_add_u32 s7, s6, 2
    v_xor_b32 v26, s7, v1
    v_lshlrev_b32 v26, 4, v26
    s_lshl_b32 s7, s7, 10
    s_add_u32 s7, s7, 135168
    v_add_u32 v26, s7, v26
    s_add_u32 s7, s6, 3
    v_xor_b32 v27, s7, v1
    v_lshlrev_b32 v27, 4, v27
    s_lshl_b32 s7, s7, 10
    s_add_u32 s7, s7, 135168
    v_add_u32 v27, s7, v27
    s_lshl_b32 s5, s75, 5
    s_lshl_b32 s6, s74, 4
    s_add_u32 s5, s5, s6
    s_lshl_b32 s6, s3, 2
    s_add_u32 s5, s5, s6
    s_lshl_b32 s5, s5, 10
    s_add_u32 s5, s5, 65536
    s_mov_b32 s82, 0
LC_pollA:
    s_sleep 8
    buffer_load_dwordx4 v[8:11], v4, s[64:67], s5 offen offset:0 sc1
    buffer_load_dwordx4 v[12:15], v4, s[64:67], s5 offen offset:1024 sc1
    buffer_load_dwordx4 v[16:19], v4, s[64:67], s5 offen offset:2048 sc1
    buffer_load_dwordx4 v[20:23], v4, s[64:67], s5 offen offset:3072 sc1
    s_waitcnt vmcnt(0)
    v_max3_u32 v28, v8, v9, v10
    v_max3_u32 v28, v28, v11, v12
    v_max3_u32 v28, v28, v13, v14
    v_max3_u32 v28, v28, v15, v16
    v_max3_u32 v28, v28, v17, v18
    v_max3_u32 v28, v28, v19, v20
    v_max3_u32 v28, v28, v21, v22
    v_max_u32 v28, v28, v23
    v_cmp_eq_u32 vcc, -1, v28
    s_add_u32 s82, s82, 1
    s_cmp_gt_u32 s82, 200000
    s_cbranch_scc1 LC_pollAd
    s_cbranch_vccnz LC_pollA
LC_pollAd:
    s_waitcnt vmcnt(0)
    v_lshlrev_b32 v29, 12, v1
    v_mov_b32 v30, 1
    s_lshl_b32 s4, s2, 2
    s_lshl_b32 s5, s3, 10
    s_add_u32 s4, s4, s5
    s_add_u32 s4, s4, 10747904
    s_mov_b64 exec, 0xffffffff
    buffer_store_dword v30, v29, s[64:67], s4 offen sc1
    s_mov_b64 exec, -1
LW3:
    ds_read_b32 v252, v250 offset:68
    s_waitcnt lgkmcnt(0)
    v_readfirstlane_b32 s79, v252
    s_cmp_lt_u32 s79, 4
    s_cbranch_scc1 LW3
    ds_write_b128 v24, v[8:11]
    ds_write_b128 v25, v[12:15]
    ds_write_b128 v26, v[16:19]
    ds_write_b128 v27, v[20:23]
    v_add_u32 v6, 0, v2
    v_xor_b32 v6, v6, v3
    v_lshlrev_b32 v6, 4, v6
    v_lshl_add_u32 v8, v3, 10, v6
    v_add_u32 v8, 135168, v8
    v_add_u32 v6, 4, v2
    v_xor_b32 v6, v6, v3
    v_lshlrev_b32 v6, 4, v6
    v_lshl_add_u32 v9, v3, 10, v6
    v_add_u32 v9, 135168, v9
    v_add_u32 v6, 8, v2
    v_xor_b32 v6, v6, v3
    v_lshlrev_b32 v6, 4, v6
    v_lshl_add_u32 v10, v3, 10, v6
    v_add_u32 v10, 135168, v10
    v_add_u32 v6, 12, v2
    v_xor_b32 v6, v6, v3
    v_lshlrev_b32 v6, 4, v6
    v_lshl_add_u32 v11, v3, 10, v6
    v_add_u32 v11, 135168, v11
    s_lshl_b32 s4, s3, 5
    v_add_u32 v12, s4, v3
    s_mov_b32 s4, 1056
    v_mul_lo_u32 v12, v12, s4
    v_lshl_add_u32 v12, v2, 4, v12
    v_mov_b32 v48, 0
    v_mov_b32 v49, 0
    v_mov_b32 v50, 0
    v_mov_b32 v51, 0
    v_mov_b32 v52, 0
    v_mov_b32 v53, 0
    v_mov_b32 v54, 0
    v_mov_b32 v55, 0
    s_waitcnt lgkmcnt(0)
    s_mov_b64 exec, 1
    ds_add_u32 v250, v251 offset:8
    s_mov_b64 exec, -1
LW4:
    ds_read_b32 v252, v250 offset:8
    s_waitcnt lgkmcnt(0)
    v_readfirstlane_b32 s79, v252
    s_cmp_lt_u32 s79, 4
    s_cbranch_scc1 LW4
    ds_read_b128 v[64:67], v8 offset:0
    ds_read_b128 v[68:71], v9 offset:0
    ds_read_b128 v[72:75], v10 offset:0
    ds_read_b128 v[76:79], v11 offset:0
    ds_read_b128 v[80:83], v8 offset:256
    ds_read_b128 v[84:87], v9 offset:256
    ds_read_b128 v[88:91], v10 offset:256
    ds_read_b128 v[92:95], v11 offset:256
    ds_read_b128 v[96:99], v8 offset:512
    ds_read_b128 v[100:103], v9 offset:512
    ds_read_b128 v[104:107], v10 offset:512
    ds_read_b128 v[108:111], v11 offset:512
    ds_read_b128 v[112:115], v8 offset:768
    ds_read_b128 v[116:119], v9 offset:768
    ds_read_b128 v[120:123], v10 offset:768
    ds_read_b128 v[124:127], v11 offset:768
LW5:
    s_sleep 1
    ds_read_b32 v252, v250 offset:4
    s_waitcnt lgkmcnt(0)
    v_readfirstlane_b32 s79, v252
    s_cmp_lt_u32 s79, 4
    s_cbranch_scc1 LW5
    ds_read_b128 v[128:131], v12 offset:0
    ds_read_b128 v[132:135], v12 offset:16896
    ds_read_b128 v[136:139], v12 offset:64
    ds_read_b128 v[140:143], v12 offset:16960
    ds_read_b128 v[144:147], v12 offset:128
    ds_read_b128 v[148:151], v12 offset:17024
    ds_read_b128 v[152:155], v12 offset:192
    ds_read_b128 v[156:159], v12 offset:17088
    ds_read_b128 v[160:163], v12 offset:256
    ds_read_b128 v[164:167], v12 offset:17152
    ds_read_b128 v[168:171], v12 offset:320
    ds_read_b128 v[172:175], v12 offset:17216
    ds_read_b128 v[176:179], v12 offset:384
    ds_read_b128 v[180:183], v12 offset:17280
    ds_read_b128 v[184:187], v12 offset:448
    ds_read_b128 v[188:191], v12 offset:17344
    s_waitcnt lgkmcnt(8)
    v_mfma_f32_16x16x32_bf16 v[48:51], v[128:131], v[64:67], v[48:51]
    v_mfma_f32_16x16x32_bf16 v[52:55], v[132:135], v[64:67], v[52:55]
    v_mfma_f32_16x16x32_bf16 v[48:51], v[136:139], v[68:71], v[48:51]
    v_mfma_f32_16x16x32_bf16 v[52:55], v[140:143], v[68:71], v[52:55]
    v_mfma_f32_16x16x32_bf16 v[48:51], v[144:147], v[72:75], v[48:51]
    v_mfma_f32_16x16x32_bf16 v[52:55], v[148:151], v[72:75], v[52:55]
    v_mfma_f32_16x16x32_bf16 v[48:51], v[152:155], v[76:79], v[48:51]
    v_mfma_f32_16x16x32_bf16 v[52:55], v[156:159], v[76:79], v[52:55]
    ds_read_b128 v[128:131], v12 offset:512
    ds_read_b128 v[132:135], v12 offset:17408
    ds_read_b128 v[136:139], v12 offset:576
    ds_read_b128 v[140:143], v12 offset:17472
    ds_read_b128 v[144:147], v12 offset:640
    ds_read_b128 v[148:151], v12 offset:17536
    ds_read_b128 v[152:155], v12 offset:704
    ds_read_b128 v[156:159], v12 offset:17600
    s_waitcnt lgkmcnt(8)
    v_mfma_f32_16x16x32_bf16 v[48:51], v[160:163], v[80:83], v[48:51]
    v_mfma_f32_16x16x32_bf16 v[52:55], v[164:167], v[80:83], v[52:55]
    v_mfma_f32_16x16x32_bf16 v[48:51], v[168:171], v[84:87], v[48:51]
    v_mfma_f32_16x16x32_bf16 v[52:55], v[172:175], v[84:87], v[52:55]
    v_mfma_f32_16x16x32_bf16 v[48:51], v[176:179], v[88:91], v[48:51]
    v_mfma_f32_16x16x32_bf16 v[52:55], v[180:183], v[88:91], v[52:55]
    v_mfma_f32_16x16x32_bf16 v[48:51], v[184:187], v[92:95], v[48:51]
    v_mfma_f32_16x16x32_bf16 v[52:55], v[188:191], v[92:95], v[52:55]
    ds_read_b128 v[160:163], v12 offset:768
    ds_read_b128 v[164:167], v12 offset:17664
    ds_read_b128 v[168:171], v12 offset:832
    ds_read_b128 v[172:175], v12 offset:17728
    ds_read_b128 v[176:179], v12 offset:896
    ds_read_b128 v[180:183], v12 offset:17792
    ds_read_b128 v[184:187], v12 offset:960
    ds_read_b128 v[188:191], v12 offset:17856
    s_waitcnt lgkmcnt(8)
    v_mfma_f32_16x16x32_bf16 v[48:51], v[128:131], v[96:99], v[48:51]
    v_mfma_f32_16x16x32_bf16 v[52:55], v[132:135], v[96:99], v[52:55]
    v_mfma_f32_16x16x32_bf16 v[48:51], v[136:139], v[100:103], v[48:51]
    v_mfma_f32_16x16x32_bf16 v[52:55], v[140:143], v[100:103], v[52:55]
    v_mfma_f32_16x16x32_bf16 v[48:51], v[144:147], v[104:107], v[48:51]
    v_mfma_f32_16x16x32_bf16 v[52:55], v[148:151], v[104:107], v[52:55]
    v_mfma_f32_16x16x32_bf16 v[48:51], v[152:155], v[108:111], v[48:51]
    v_mfma_f32_16x16x32_bf16 v[52:55], v[156:159], v[108:111], v[52:55]
    s_waitcnt lgkmcnt(0)
    v_mfma_f32_16x16x32_bf16 v[48:51], v[160:163], v[112:115], v[48:51]
    v_mfma_f32_16x16x32_bf16 v[52:55], v[164:167], v[112:115], v[52:55]
    v_mfma_f32_16x16x32_bf16 v[48:51], v[168:171], v[116:119], v[48:51]
    v_mfma_f32_16x16x32_bf16 v[52:55], v[172:175], v[116:119], v[52:55]
    v_mfma_f32_16x16x32_bf16 v[48:51], v[176:179], v[120:123], v[48:51]
    v_mfma_f32_16x16x32_bf16 v[52:55], v[180:183], v[120:123], v[52:55]
    v_mfma_f32_16x16x32_bf16 v[48:51], v[184:187], v[124:127], v[48:51]
    v_mfma_f32_16x16x32_bf16 v[52:55], v[188:191], v[124:127], v[52:55]
    v_lshlrev_b32 v13, 6, v3
    v_lshl_add_u32 v14, v2, 2, v13
    s_lshl_b32 s4, s3, 4
    v_add_u32 v14, s4, v14
    v_add_u32 v15, 159744, v14
    v_add_u32 v16, 159744, v13
    s_nop 3
    v_cvt_pk_bf16_f32 v56, v48, v48
    v_lshlrev_b32 v48, 16, v56
    v_mul_f32 v48, 0x3db504f3, v48
    v_cvt_pk_bf16_f32 v56, v48, v48
    v_lshlrev_b32 v48, 16, v56
    v_cvt_pk_bf16_f32 v56, v49, v49
    v_lshlrev_b32 v49, 16, v56
    v_mul_f32 v49, 0x3db504f3, v49
    v_cvt_pk_bf16_f32 v56, v49, v49
    v_lshlrev_b32 v49, 16, v56
    v_cvt_pk_bf16_f32 v56, v50, v50
    v_lshlrev_b32 v50, 16, v56
    v_mul_f32 v50, 0x3db504f3, v50
    v_cvt_pk_bf16_f32 v56, v50, v50
    v_lshlrev_b32 v50, 16, v56
    v_cvt_pk_bf16_f32 v56, v51, v51
    v_lshlrev_b32 v51, 16, v56
    v_mul_f32 v51, 0x3db504f3, v51
    v_cvt_pk_bf16_f32 v56, v51, v51
    v_lshlrev_b32 v51, 16, v56
    v_cvt_pk_bf16_f32 v56, v52, v52
    v_lshlrev_b32 v52, 16, v56
    v_mul_f32 v52, 0x3db504f3, v52
    v_cvt_pk_bf16_f32 v56, v52, v52
    v_lshlrev_b32 v52, 16, v56
    v_cvt_pk_bf16_f32 v56, v53, v53
    v_lshlrev_b32 v53, 16, v56
    v_mul_f32 v53, 0x3db504f3, v53
    v_cvt_pk_bf16_f32 v56, v53, v53
    v_lshlrev_b32 v53, 16, v56
    v_cvt_pk_bf16_f32 v56, v54, v54
    v_lshlrev_b32 v54, 16, v56
    v_mul_f32 v54, 0x3db504f3, v54
    v_cvt_pk_bf16_f32 v56, v54, v54
    v_lshlrev_b32 v54, 16, v56
    v_cvt_pk_bf16_f32 v56, v55, v55
    v_lshlrev_b32 v55, 16, v56
    v_mul_f32 v55, 0x3db504f3, v55
    v_cvt_pk_bf16_f32 v56, v55, v55
    v_lshlrev_b32 v55, 16, v56
    v_max3_f32 v56, v48, v49, v50
    v_max3_f32 v56, v56, v51, v52
    v_max3_f32 v56, v56, v53, v54
    v_max_f32 v56, v56, v55
    ds_write_b32 v15, v56
    s_waitcnt lgkmcnt(0)
    s_mov_b64 exec, 1
    ds_add_u32 v250, v251 offset:12
    s_mov_b64 exec, -1
LW6:
    ds_read_b32 v252, v250 offset:12
    s_waitcnt lgkmcnt(0)
    v_readfirstlane_b32 s79, v252
    s_cmp_lt_u32 s79, 4
    s_cbranch_scc1 LW6
    ds_read_b128 v[128:131], v16 offset:0
    ds_read_b128 v[132:135], v16 offset:16
    ds_read_b128 v[136:139], v16 offset:32
    ds_read_b128 v[140:143], v16 offset:48
    s_waitcnt lgkmcnt(0)
    v_max3_f32 v57, v128, v129, v130
    v_max3_f32 v57, v57, v131, v132
    v_max3_f32 v57, v57, v133, v134
    v_max3_f32 v57, v57, v135, v136
    v_max3_f32 v57, v57, v137, v138
    v_max3_f32 v57, v57, v139, v140
    v_max3_f32 v57, v57, v141, v142
    v_max_f32 v57, v57, v143
    v_sub_f32 v48, v48, v57
    v_mul_f32 v48, 0x3fb8aa3b, v48
    v_exp_f32 v48, v48
    v_sub_f32 v49, v49, v57
    v_mul_f32 v49, 0x3fb8aa3b, v49
    v_exp_f32 v49, v49
    v_sub_f32 v50, v50, v57
    v_mul_f32 v50, 0x3fb8aa3b, v50
    v_exp_f32 v50, v50
    v_sub_f32 v51, v51, v57
    v_mul_f32 v51, 0x3fb8aa3b, v51
    v_exp_f32 v51, v51
    v_sub_f32 v52, v52, v57
    v_mul_f32 v52, 0x3fb8aa3b, v52
    v_exp_f32 v52, v52
    v_sub_f32 v53, v53, v57
    v_mul_f32 v53, 0x3fb8aa3b, v53
    v_exp_f32 v53, v53
    v_sub_f32 v54, v54, v57
    v_mul_f32 v54, 0x3fb8aa3b, v54
    v_exp_f32 v54, v54
    v_sub_f32 v55, v55, v57
    v_mul_f32 v55, 0x3fb8aa3b, v55
    v_exp_f32 v55, v55
    s_nop 0
    v_add_f32 v58, v48, v49
    v_add_f32 v58, v58, v50
    v_add_f32 v58, v58, v51
    v_add_f32 v58, v58, v52
    v_add_f32 v58, v58, v53
    v_add_f32 v58, v58, v54
    v_add_f32 v58, v58, v55
    v_cvt_pk_bf16_f32 v60, v48, v49
    v_cvt_pk_bf16_f32 v61, v50, v51
    v_cvt_pk_bf16_f32 v62, v52, v53
    v_cvt_pk_bf16_f32 v63, v54, v55
    v_add_u32 v15, 160768, v14
    ds_write_b32 v15, v58
    s_lshl_b32 s4, s3, 10
    s_add_u32 s4, s4, 155648
    v_add_u32 v17, s4, v4
    ds_write_b128 v17, v[60:63]
    v_add_u32 v17, 155648, v4
    v_lshl_add_u32 v18, v2, 2, v40
    s_mov_b32 s4, 1056
    v_mul_lo_u32 v18, v18, s4
    s_lshl_b32 s4, s3, 8
    v_add_u32 v18, s4, v18
    v_lshl_add_u32 v20, v41, 4, v18
    v_add_u32 v21, 67584, v20
    v_lshl_add_u32 v18, v41, 3, v18
    v_add_u32 v19, 67584, v18
    s_waitcnt lgkmcnt(0)
    s_mov_b64 exec, 1
    ds_add_u32 v250, v251 offset:16
    s_mov_b64 exec, -1
LW7:
    ds_read_b32 v252, v250 offset:16
    s_waitcnt lgkmcnt(0)
    v_readfirstlane_b32 s79, v252
    s_cmp_lt_u32 s79, 4
    s_cbranch_scc1 LW7
    ds_read_b128 v[64:67], v17 offset:0
    ds_read_b128 v[68:71], v17 offset:1024
    ds_read_b128 v[72:75], v17 offset:2048
    ds_read_b128 v[76:79], v17 offset:3072
    v_add_u32 v16, 160768, v13
    ds_read_b128 v[80:83], v16 offset:0
    ds_read_b128 v[84:87], v16 offset:16
    ds_read_b128 v[88:91], v16 offset:32
    ds_read_b128 v[92:95], v16 offset:48
    ds_read_b64_tr_b16 v[128:129], v20 offset:0
    ds_read_b64_tr_b16 v[130:131], v20 offset:16896
    ds_read_b64_tr_b16 v[132:133], v20 offset:33792
    ds_read_b64_tr_b16 v[134:135], v20 offset:50688
    ds_read_b64_tr_b16 v[136:137], v21 offset:0
    ds_read_b64_tr_b16 v[138:139], v21 offset:16896
    ds_read_b64_tr_b16 v[140:141], v21 offset:33792
    ds_read_b64_tr_b16 v[142:143], v21 offset:50688
    ds_read_b64_tr_b16 v[144:145], v20 offset:8
    ds_read_b64_tr_b16 v[146:147], v20 offset:16904
    ds_read_b64_tr_b16 v[148:149], v20 offset:33800
    ds_read_b64_tr_b16 v[150:151], v20 offset:50696
    ds_read_b64_tr_b16 v[152:153], v21 offset:8
    ds_read_b64_tr_b16 v[154:155], v21 offset:16904
    ds_read_b64_tr_b16 v[156:157], v21 offset:33800
    ds_read_b64_tr_b16 v[158:159], v21 offset:50696
    s_waitcnt lgkmcnt(8)
    v_mfma_f32_16x16x32_bf16 v[192:195], v[128:131], v[64:67], 0
    v_mfma_f32_16x16x32_bf16 v[192:195], v[132:135], v[68:71], v[192:195]
    v_mfma_f32_16x16x32_bf16 v[192:195], v[136:139], v[72:75], v[192:195]
    v_mfma_f32_16x16x32_bf16 v[192:195], v[140:143], v[76:79], v[192:195]
    ds_read_b64_tr_b16 v[128:129], v20 offset:64
    ds_read_b64_tr_b16 v[130:131], v20 offset:16960
    ds_read_b64_tr_b16 v[132:133], v20 offset:33856
    ds_read_b64_tr_b16 v[134:135], v20 offset:50752
    ds_read_b64_tr_b16 v[136:137], v21 offset:64
    ds_read_b64_tr_b16 v[138:139], v21 offset:16960
    ds_read_b64_tr_b16 v[140:141], v21 offset:33856
    ds_read_b64_tr_b16 v[142:143], v21 offset:50752
    s_waitcnt lgkmcnt(8)
    v_mfma_f32_16x16x32_bf16 v[196:199], v[144:147], v[64:67], 0
    v_mfma_f32_16x16x32_bf16 v[196:199], v[148:151], v[68:71], v[196:199]
    v_mfma_f32_16x16x32_bf16 v[196:199], v[152:155], v[72:75], v[196:199]
    v_mfma_f32_16x16x32_bf16 v[196:199], v[156:159], v[76:79], v[196:199]
    ds_read_b64_tr_b16 v[144:145], v20 offset:72
    ds_read_b64_tr_b16 v[146:147], v20 offset:16968
    ds_read_b64_tr_b16 v[148:149], v20 offset:33864
    ds_read_b64_tr_b16 v[150:151], v20 offset:50760
    ds_read_b64_tr_b16 v[152:153], v21 offset:72
    ds_read_b64_tr_b16 v[154:155], v21 offset:16968
    ds_read_b64_tr_b16 v[156:157], v21 offset:33864
    ds_read_b64_tr_b16 v[158:159], v21 offset:50760
    s_waitcnt lgkmcnt(8)
    v_mfma_f32_16x16x32_bf16 v[200:203], v[128:131], v[64:67], 0
    v_mfma_f32_16x16x32_bf16 v[200:203], v[132:135], v[68:71], v[200:203]
    v_mfma_f32_16x16x32_bf16 v[200:203], v[136:139], v[72:75], v[200:203]
    v_mfma_f32_16x16x32_bf16 v[200:203], v[140:143], v[76:79], v[200:203]
    ds_read_b64_tr_b16 v[128:129], v20 offset:128
    ds_read_b64_tr_b16 v[130:131], v20 offset:17024
    ds_read_b64_tr_b16 v[132:133], v20 offset:33920
    ds_read_b64_tr_b16 v[134:135], v20 offset:50816
    ds_read_b64_tr_b16 v[136:137], v21 offset:128
    ds_read_b64_tr_b16 v[138:139], v21 offset:17024
    ds_read_b64_tr_b16 v[140:141], v21 offset:33920
    ds_read_b64_tr_b16 v[142:143], v21 offset:50816
    s_waitcnt lgkmcnt(8)
    v_mfma_f32_16x16x32_bf16 v[204:207], v[144:147], v[64:67], 0
    v_mfma_f32_16x16x32_bf16 v[204:207], v[148:151], v[68:71], v[204:207]
    v_mfma_f32_16x16x32_bf16 v[204:207], v[152:155], v[72:75], v[204:207]
    v_mfma_f32_16x16x32_bf16 v[204:207], v[156:159], v[76:79], v[204:207]
    ds_read_b64_tr_b16 v[144:145], v20 offset:136
    ds_read_b64_tr_b16 v[146:147], v20 offset:17032
    ds_read_b64_tr_b16 v[148:149], v20 offset:33928
    ds_read_b64_tr_b16 v[150:151], v20 offset:50824
    ds_read_b64_tr_b16 v[152:153], v21 offset:136
    ds_read_b64_tr_b16 v[154:155], v21 offset:17032
    ds_read_b64_tr_b16 v[156:157], v21 offset:33928
    ds_read_b64_tr_b16 v[158:159], v21 offset:50824
    s_waitcnt lgkmcnt(8)
    v_mfma_f32_16x16x32_bf16 v[208:211], v[128:131], v[64:67], 0
    v_mfma_f32_16x16x32_bf16 v[208:211], v[132:135], v[68:71], v[208:211]
    v_mfma_f32_16x16x32_bf16 v[208:211], v[136:139], v[72:75], v[208:211]
    v_mfma_f32_16x16x32_bf16 v[208:211], v[140:143], v[76:79], v[208:211]
    ds_read_b64_tr_b16 v[128:129], v20 offset:192
    ds_read_b64_tr_b16 v[130:131], v20 offset:17088
    ds_read_b64_tr_b16 v[132:133], v20 offset:33984
    ds_read_b64_tr_b16 v[134:135], v20 offset:50880
    ds_read_b64_tr_b16 v[136:137], v21 offset:192
    ds_read_b64_tr_b16 v[138:139], v21 offset:17088
    ds_read_b64_tr_b16 v[140:141], v21 offset:33984
    ds_read_b64_tr_b16 v[142:143], v21 offset:50880
    s_waitcnt lgkmcnt(8)
    v_mfma_f32_16x16x32_bf16 v[212:215], v[144:147], v[64:67], 0
    v_mfma_f32_16x16x32_bf16 v[212:215], v[148:151], v[68:71], v[212:215]
    v_mfma_f32_16x16x32_bf16 v[212:215], v[152:155], v[72:75], v[212:215]
    v_mfma_f32_16x16x32_bf16 v[212:215], v[156:159], v[76:79], v[212:215]
    ds_read_b64_tr_b16 v[144:145], v20 offset:200
    ds_read_b64_tr_b16 v[146:147], v20 offset:17096
    ds_read_b64_tr_b16 v[148:149], v20 offset:33992
    ds_read_b64_tr_b16 v[150:151], v20 offset:50888
    ds_read_b64_tr_b16 v[152:153], v21 offset:200
    ds_read_b64_tr_b16 v[154:155], v21 offset:17096
    ds_read_b64_tr_b16 v[156:157], v21 offset:33992
    ds_read_b64_tr_b16 v[158:159], v21 offset:50888
    s_waitcnt lgkmcnt(8)
    v_mfma_f32_16x16x32_bf16 v[216:219], v[128:131], v[64:67], 0
    v_mfma_f32_16x16x32_bf16 v[216:219], v[132:135], v[68:71], v[216:219]
    v_mfma_f32_16x16x32_bf16 v[216:219], v[136:139], v[72:75], v[216:219]
    v_mfma_f32_16x16x32_bf16 v[216:219], v[140:143], v[76:79], v[216:219]
    s_waitcnt lgkmcnt(0)
    v_mfma_f32_16x16x32_bf16 v[220:223], v[144:147], v[64:67], 0
    v_mfma_f32_16x16x32_bf16 v[220:223], v[148:151], v[68:71], v[220:223]
    v_mfma_f32_16x16x32_bf16 v[220:223], v[152:155], v[72:75], v[220:223]
    v_mfma_f32_16x16x32_bf16 v[220:223], v[156:159], v[76:79], v[220:223]
    s_mov_b64 exec, 1
    ds_add_u32 v250, v251 offset:44
    s_mov_b64 exec, -1
    v_add_f32 v59, v80, v81
    v_add_f32 v59, v59, v82
    v_add_f32 v59, v59, v83
    v_add_f32 v59, v59, v84
    v_add_f32 v59, v59, v85
    v_add_f32 v59, v59, v86
    v_add_f32 v59, v59, v87
    v_add_f32 v59, v59, v88
    v_add_f32 v59, v59, v89
    v_add_f32 v59, v59, v90
    v_add_f32 v59, v59, v91
    v_add_f32 v59, v59, v92
    v_add_f32 v59, v59, v93
    v_add_f32 v59, v59, v94
    v_add_f32 v59, v59, v95
    v_mov_b32 v58, v57
    v_lshlrev_b32 v22, 17, v3
    v_lshl_add_u32 v22, v2, 4, v22
    s_lshl_b32 s4, s74, 21
    s_lshl_b32 s5, s3, 15
    s_add_u32 s4, s4, s5
    s_lshl_b32 s5, s75, 12
    s_add_u32 s4, s4, s5
    s_lshl_b32 s5, s76, 7
    s_add_u32 s4, s4, s5
    s_add_u32 s4, s4, 2097152
    s_add_u32 s5, s4, 16384
    v_cvt_pk_bf16_f32 v128, v192, v193
    v_cvt_pk_bf16_f32 v129, v194, v195
    v_cvt_pk_bf16_f32 v130, v196, v197
    v_cvt_pk_bf16_f32 v131, v198, v199
    buffer_store_dwordx4 v[128:131], v22, s[64:67], s4 offen offset:0 sc1
    v_cvt_pk_bf16_f32 v132, v200, v201
    v_cvt_pk_bf16_f32 v133, v202, v203
    v_cvt_pk_bf16_f32 v134, v204, v205
    v_cvt_pk_bf16_f32 v135, v206, v207
    buffer_store_dwordx4 v[132:135], v22, s[64:67], s4 offen offset:64 sc1
    v_cvt_pk_bf16_f32 v136, v208, v209
    v_cvt_pk_bf16_f32 v137, v210, v211
    v_cvt_pk_bf16_f32 v138, v212, v213
    v_cvt_pk_bf16_f32 v139, v214, v215
    buffer_store_dwordx4 v[136:139], v22, s[64:67], s5 offen offset:0 sc1
    v_cvt_pk_bf16_f32 v140, v216, v217
    v_cvt_pk_bf16_f32 v141, v218, v219
    v_cvt_pk_bf16_f32 v142, v220, v221
    v_cvt_pk_bf16_f32 v143, v222, v223
    buffer_store_dwordx4 v[140:143], v22, s[64:67], s5 offen offset:64 sc1
    v_lshlrev_b32 v21, 12, v3
    s_lshl_b32 s4, s74, 16
    s_lshl_b32 s5, s3, 10
    s_add_u32 s4, s4, s5
    s_lshl_b32 s5, s75, 8
    s_add_u32 s4, s4, s5
    s_lshl_b32 s5, s76, 3
    s_add_u32 s4, s4, s5
    s_add_u32 s4, s4, 10485760
    s_waitcnt vmcnt(0)
    s_mov_b64 exec, 0xffff
    buffer_store_dwordx2 v[58:59], v21, s[64:67], s4 offen sc1
    s_mov_b64 exec, -1
    s_lshr_b32 s80, s2, 6
    s_and_b32 s81, s2, 63
    v_and_b32 v230, 7, v1
    v_lshlrev_b32 v230, 2, v230
    v_lshrrev_b32 v5, 3, v1
    v_lshl_add_u32 v230, v5, 13, v230
    s_lshl_b32 s4, s3, 19
    s_lshl_b32 s5, s80, 11
    s_add_u32 s4, s4, s5
    s_lshl_b32 s5, s81, 5
    s_add_u32 s83, s4, s5
    s_and_b32 s4, s2, 31
    s_lshl_b32 s4, s4, 12
    s_lshr_b32 s5, s81, 4
    s_lshl_b32 s5, s5, 10
    s_add_u32 s4, s4, s5
    s_lshl_b32 s5, s3, 8
    s_add_u32 s15, s4, s5
    s_add_u32 s4, s15, 10747904
    v_lshlrev_b32 v231, 2, v1
    s_mov_b32 s82, 0
LC_pollY:
    buffer_load_dword v6, v231, s[64:67], s4 offen sc1
    s_waitcnt vmcnt(0)
    v_cmp_ne_u32 vcc, 1, v6
    s_add_u32 s82, s82, 1
    s_cmp_gt_u32 s82, 200000
    s_cbranch_scc1 LC_pollYd
    s_cbranch_vccnz LC_pollY
LC_pollYd:
    s_add_u32 s6, s83, 8388608
    v_mov_b32 v28, 0
    v_mov_b32 v29, 0
    v_mov_b32 v30, 0
    v_mov_b32 v31, 0
    buffer_load_dword v24, v230, s[64:67], s6 offen sc1
    s_add_u32 s6, s6, 65536
    buffer_load_dword v25, v230, s[64:67], s6 offen sc1
    s_add_u32 s6, s6, 65536
    buffer_load_dword v26, v230, s[64:67], s6 offen sc1
    s_add_u32 s6, s6, 65536
    buffer_load_dword v27, v230, s[64:67], s6 offen sc1
    s_add_u32 s6, s6, 65536
    s_cmp_eq_u32 s3, 3
    s_cbranch_scc1 LC_y8
    buffer_load_dword v28, v230, s[64:67], s6 offen sc1
    s_add_u32 s6, s6, 65536
    buffer_load_dword v29, v230, s[64:67], s6 offen sc1
    s_add_u32 s6, s6, 65536
    buffer_load_dword v30, v230, s[64:67], s6 offen sc1
    s_add_u32 s6, s6, 65536
    buffer_load_dword v31, v230, s[64:67], s6 offen sc1
    s_add_u32 s6, s6, 65536
LC_y8:
    s_waitcnt vmcnt(0)
    v_add_f32 v24, v24, v25
    v_add_f32 v24, v24, v26
    v_add_f32 v24, v24, v27
    v_add_f32 v24, v24, v28
    v_add_f32 v24, v24, v29
    v_add_f32 v24, v24, v30
    v_add_f32 v24, v24, v31
    v_mov_b32 v229, v24
    v_lshlrev_b32 v36, 11, v41
    v_lshl_add_u32 v36, v2, 4, v36
    v_and_b32 v5, 31, v1
    v_lshlrev_b32 v5, 3, v5
    s_lshl_b32 s80, s68, 12
    s_lshr_b32 s5, s69, 1
    s_lshl_b32 s5, s5, 10
    s_add_u32 s80, s80, s5
    s_lshl_b32 s5, s3, 8
    s_add_u32 s80, s80, s5
    s_add_u32 s80, s80, 10485760
    v_lshlrev_b32 v6, 1, v1
    s_lshl_b32 s81, s68, 17
    s_lshl_b32 s5, s69, 14
    s_add_u32 s81, s81, s5
    s_lshl_b32 s5, s3, 12
    s_add_u32 s81, s81, s5
    s_add_u32 s81, s81, 2097152
    s_mov_b32 s82, 0
LC_pollml:
    s_sleep 2
    buffer_load_dwordx2 v[8:9], v5, s[64:67], s80 offen sc1
    s_waitcnt vmcnt(0)
    v_add_f32 v10, v8, v9
    v_cmp_u_f32 vcc, v10, v10
    s_add_u32 s82, s82, 1
    s_cmp_gt_u32 s82, 200000
    s_cbranch_scc1 LC_pollO
    s_cbranch_vccnz LC_pollml
LC_pollO:
    buffer_load_ushort v64, v6, s[64:67], s81 offen offset:0 sc1
    buffer_load_ushort v65, v6, s[64:67], s81 offen offset:128 sc1
    buffer_load_ushort v66, v6, s[64:67], s81 offen offset:256 sc1
    buffer_load_ushort v67, v6, s[64:67], s81 offen offset:384 sc1
    buffer_load_ushort v68, v6, s[64:67], s81 offen offset:512 sc1
    buffer_load_ushort v69, v6, s[64:67], s81 offen offset:640 sc1
    buffer_load_ushort v70, v6, s[64:67], s81 offen offset:768 sc1
    buffer_load_ushort v71, v6, s[64:67], s81 offen offset:896 sc1
    buffer_load_ushort v72, v6, s[64:67], s81 offen offset:1024 sc1
    buffer_load_ushort v73, v6, s[64:67], s81 offen offset:1152 sc1
    buffer_load_ushort v74, v6, s[64:67], s81 offen offset:1280 sc1
    buffer_load_ushort v75, v6, s[64:67], s81 offen offset:1408 sc1
    buffer_load_ushort v76, v6, s[64:67], s81 offen offset:1536 sc1
    buffer_load_ushort v77, v6, s[64:67], s81 offen offset:1664 sc1
    buffer_load_ushort v78, v6, s[64:67], s81 offen offset:1792 sc1
    buffer_load_ushort v79, v6, s[64:67], s81 offen offset:1920 sc1
    buffer_load_ushort v80, v6, s[64:67], s81 offen offset:2048 sc1
    buffer_load_ushort v81, v6, s[64:67], s81 offen offset:2176 sc1
    buffer_load_ushort v82, v6, s[64:67], s81 offen offset:2304 sc1
    buffer_load_ushort v83, v6, s[64:67], s81 offen offset:2432 sc1
    buffer_load_ushort v84, v6, s[64:67], s81 offen offset:2560 sc1
    buffer_load_ushort v85, v6, s[64:67], s81 offen offset:2688 sc1
    buffer_load_ushort v86, v6, s[64:67], s81 offen offset:2816 sc1
    buffer_load_ushort v87, v6, s[64:67], s81 offen offset:2944 sc1
    buffer_load_ushort v88, v6, s[64:67], s81 offen offset:3072 sc1
    buffer_load_ushort v89, v6, s[64:67], s81 offen offset:3200 sc1
    buffer_load_ushort v90, v6, s[64:67], s81 offen offset:3328 sc1
    buffer_load_ushort v91, v6, s[64:67], s81 offen offset:3456 sc1
    buffer_load_ushort v92, v6, s[64:67], s81 offen offset:3584 sc1
    buffer_load_ushort v93, v6, s[64:67], s81 offen offset:3712 sc1
    buffer_load_ushort v94, v6, s[64:67], s81 offen offset:3840 sc1
    buffer_load_ushort v95, v6, s[64:67], s81 offen offset:3968 sc1
    v_mov_b32 v17, v8
    s_nop 1
    v_max_f32_dpp v17, v17, v17 row_shr:1 row_mask:0xf bank_mask:0xf
    s_nop 1
    v_max_f32_dpp v17, v17, v17 row_shr:2 row_mask:0xf bank_mask:0xf
    s_nop 1
    v_max_f32_dpp v17, v17, v17 row_shr:4 row_mask:0xf bank_mask:0xf
    s_nop 1
    v_max_f32_dpp v17, v17, v17 row_shr:8 row_mask:0xf bank_mask:0xf
    s_nop 1
    v_max_f32_dpp v17, v17, v17 row_bcast:15 row_mask:0xa bank_mask:0xf
    s_nop 1
    v_max_f32_dpp v17, v17, v17 row_bcast:31 row_mask:0xc bank_mask:0xf
    s_nop 1
    v_readlane_b32 s72, v17, 63
    s_nop 3
    v_subrev_f32 v17, s72, v8
    v_mul_f32 v17, 0x3fb8aa3b, v17
    v_exp_f32 v17, v17
    s_nop 0
    v_mul_f32 v10, v17, v9
    s_nop 1
    v_add_f32_dpp v10, v10, v10 row_shr:1 row_mask:0xf bank_mask:0xf
    s_nop 1
    v_add_f32_dpp v10, v10, v10 row_shr:2 row_mask:0xf bank_mask:0xf
    s_nop 1
    v_add_f32_dpp v10, v10, v10 row_shr:4 row_mask:0xf bank_mask:0xf
    s_nop 1
    v_add_f32_dpp v10, v10, v10 row_shr:8 row_mask:0xf bank_mask:0xf
    s_nop 1
    v_add_f32_dpp v10, v10, v10 row_bcast:15 row_mask:0xa bank_mask:0xf
    s_nop 1
    v_add_f32_dpp v10, v10, v10 row_bcast:31 row_mask:0xc bank_mask:0xf
    s_nop 1
    v_readlane_b32 s73, v10, 63
    s_nop 3
    v_mov_b32 v20, s73
    v_mul_f32 v20, 0.5, v20
    v_rcp_f32 v20, v20
    v_and_b32 v21, 0x23, v1
    v_bfe_u32 v22, v1, 2, 2
    v_lshl_add_u32 v21, v22, 3, v21
    v_bfe_u32 v22, v1, 4, 1
    v_lshl_add_u32 v21, v22, 2, v21
    v_lshlrev_b32 v21, 1, v21
    s_lshl_b32 s12, s3, 7
    s_add_u32 s12, s12, 151552
    v_add_u32 v21, s12, v21
    v_mov_b32 v11, 0
    v_readlane_b32 s4, v17, 0
    v_readlane_b32 s5, v17, 1
    v_readlane_b32 s6, v17, 2
    v_readlane_b32 s7, v17, 3
    v_readlane_b32 s8, v17, 4
    v_readlane_b32 s9, v17, 5
    v_readlane_b32 s10, v17, 6
    v_readlane_b32 s11, v17, 7
    s_waitcnt vmcnt(24)
    v_lshlrev_b32 v64, 16, v64
    v_fmac_f32 v11, s4, v64
    v_lshlrev_b32 v65, 16, v65
    v_fmac_f32 v11, s5, v65
    v_lshlrev_b32 v66, 16, v66
    v_fmac_f32 v11, s6, v66
    v_lshlrev_b32 v67, 16, v67
    v_fmac_f32 v11, s7, v67
    v_lshlrev_b32 v68, 16, v68
    v_fmac_f32 v11, s8, v68
    v_lshlrev_b32 v69, 16, v69
    v_fmac_f32 v11, s9, v69
    v_lshlrev_b32 v70, 16, v70
    v_fmac_f32 v11, s10, v70
    v_lshlrev_b32 v71, 16, v71
    v_fmac_f32 v11, s11, v71
    v_readlane_b32 s4, v17, 8
    v_readlane_b32 s5, v17, 9
    v_readlane_b32 s6, v17, 10
    v_readlane_b32 s7, v17, 11
    v_readlane_b32 s8, v17, 12
    v_readlane_b32 s9, v17, 13
    v_readlane_b32 s10, v17, 14
    v_readlane_b32 s11, v17, 15
    s_waitcnt vmcnt(16)
    v_lshlrev_b32 v72, 16, v72
    v_fmac_f32 v11, s4, v72
    v_lshlrev_b32 v73, 16, v73
    v_fmac_f32 v11, s5, v73
    v_lshlrev_b32 v74, 16, v74
    v_fmac_f32 v11, s6, v74
    v_lshlrev_b32 v75, 16, v75
    v_fmac_f32 v11, s7, v75
    v_lshlrev_b32 v76, 16, v76
    v_fmac_f32 v11, s8, v76
    v_lshlrev_b32 v77, 16, v77
    v_fmac_f32 v11, s9, v77
    v_lshlrev_b32 v78, 16, v78
    v_fmac_f32 v11, s10, v78
    v_lshlrev_b32 v79, 16, v79
    v_fmac_f32 v11, s11, v79
    v_readlane_b32 s4, v17, 16
    v_readlane_b32 s5, v17, 17
    v_readlane_b32 s6, v17, 18
    v_readlane_b32 s7, v17, 19
    v_readlane_b32 s8, v17, 20
    v_readlane_b32 s9, v17, 21
    v_readlane_b32 s10, v17, 22
    v_readlane_b32 s11, v17, 23
    s_waitcnt vmcnt(8)
    v_lshlrev_b32 v80, 16, v80
    v_fmac_f32 v11, s4, v80
    v_lshlrev_b32 v81, 16, v81
    v_fmac_f32 v11, s5, v81
    v_lshlrev_b32 v82, 16, v82
    v_fmac_f32 v11, s6, v82
    v_lshlrev_b32 v83, 16, v83
    v_fmac_f32 v11, s7, v83
    v_lshlrev_b32 v84, 16, v84
    v_fmac_f32 v11, s8, v84
    v_lshlrev_b32 v85, 16, v85
    v_fmac_f32 v11, s9, v85
    v_lshlrev_b32 v86, 16, v86
    v_fmac_f32 v11, s10, v86
    v_lshlrev_b32 v87, 16, v87
    v_fmac_f32 v11, s11, v87
    v_readlane_b32 s4, v17, 24
    v_readlane_b32 s5, v17, 25
    v_readlane_b32 s6, v17, 26
    v_readlane_b32 s7, v17, 27
    v_readlane_b32 s8, v17, 28
    v_readlane_b32 s9, v17, 29
    v_readlane_b32 s10, v17, 30
    v_readlane_b32 s11, v17, 31
    s_waitcnt vmcnt(0)
    v_lshlrev_b32 v88, 16, v88
    v_fmac_f32 v11, s4, v88
    v_lshlrev_b32 v89, 16, v89
    v_fmac_f32 v11, s5, v89
    v_lshlrev_b32 v90, 16, v90
    v_fmac_f32 v11, s6, v90
    v_lshlrev_b32 v91, 16, v91
    v_fmac_f32 v11, s7, v91
    v_lshlrev_b32 v92, 16, v92
    v_fmac_f32 v11, s8, v92
    v_lshlrev_b32 v93, 16, v93
    v_fmac_f32 v11, s9, v93
    v_lshlrev_b32 v94, 16, v94
    v_fmac_f32 v11, s10, v94
    v_lshlrev_b32 v95, 16, v95
    v_fmac_f32 v11, s11, v95
    v_mul_f32 v11, v11, v20
    v_cvt_pk_bf16_f32 v11, v11, v11
    ds_write_b16 v21, v11
    s_waitcnt lgkmcnt(0)
    s_mov_b64 exec, 1
    ds_add_u32 v250, v251 offset:32
    s_mov_b64 exec, -1
LW8:
    s_sleep 1
    ds_read_b32 v252, v250 offset:24
    s_waitcnt lgkmcnt(0)
    v_readfirstlane_b32 s79, v252
    s_cmp_lt_u32 s79, 4
    s_cbranch_scc1 LW8
    v_add_u32 v24, 135168, v43
    v_xor_b32 v25, 0, v42
    v_lshl_add_u32 v25, v25, 5, v24
    ds_read_b64_tr_b16 v[128:129], v25 offset:0
    ds_read_b64_tr_b16 v[130:131], v25 offset:4096
    ds_read_b64_tr_b16 v[132:133], v25 offset:8192
    ds_read_b64_tr_b16 v[134:135], v25 offset:12288
    v_xor_b32 v25, 1, v42
    v_lshl_add_u32 v25, v25, 5, v24
    ds_read_b64_tr_b16 v[136:137], v25 offset:0
    ds_read_b64_tr_b16 v[138:139], v25 offset:4096
    ds_read_b64_tr_b16 v[140:141], v25 offset:8192
    ds_read_b64_tr_b16 v[142:143], v25 offset:12288
    s_waitcnt lgkmcnt(4)
    v_xor_b32 v25, 2, v42
    v_lshl_add_u32 v25, v25, 5, v24
    ds_read_b64_tr_b16 v[144:145], v25 offset:0
    ds_read_b64_tr_b16 v[146:147], v25 offset:4096
    ds_read_b64_tr_b16 v[148:149], v25 offset:8192
    ds_read_b64_tr_b16 v[150:151], v25 offset:12288
    v_xor_b32 v25, 3, v42
    v_lshl_add_u32 v25, v25, 5, v24
    ds_read_b64_tr_b16 v[152:153], v25 offset:0
    ds_read_b64_tr_b16 v[154:155], v25 offset:4096
    ds_read_b64_tr_b16 v[156:157], v25 offset:8192
    ds_read_b64_tr_b16 v[158:159], v25 offset:12288
    s_waitcnt lgkmcnt(4)
    v_xor_b32 v25, 4, v42
    v_lshl_add_u32 v25, v25, 5, v24
    ds_read_b64_tr_b16 v[160:161], v25 offset:0
    ds_read_b64_tr_b16 v[162:163], v25 offset:4096
    ds_read_b64_tr_b16 v[164:165], v25 offset:8192
    ds_read_b64_tr_b16 v[166:167], v25 offset:12288
    v_xor_b32 v25, 5, v42
    v_lshl_add_u32 v25, v25, 5, v24
    ds_read_b64_tr_b16 v[168:169], v25 offset:0
    ds_read_b64_tr_b16 v[170:171], v25 offset:4096
    ds_read_b64_tr_b16 v[172:173], v25 offset:8192
    ds_read_b64_tr_b16 v[174:175], v25 offset:12288
    s_waitcnt lgkmcnt(4)
    v_xor_b32 v25, 6, v42
    v_lshl_add_u32 v25, v25, 5, v24
    ds_read_b64_tr_b16 v[176:177], v25 offset:0
    ds_read_b64_tr_b16 v[178:179], v25 offset:4096
    ds_read_b64_tr_b16 v[180:181], v25 offset:8192
    ds_read_b64_tr_b16 v[182:183], v25 offset:12288
    v_xor_b32 v25, 7, v42
    v_lshl_add_u32 v25, v25, 5, v24
    ds_read_b64_tr_b16 v[184:185], v25 offset:0
    ds_read_b64_tr_b16 v[186:187], v25 offset:4096
    ds_read_b64_tr_b16 v[188:189], v25 offset:8192
    ds_read_b64_tr_b16 v[190:191], v25 offset:12288
    s_waitcnt lgkmcnt(4)
    v_lshlrev_b32 v22, 7, v41
    v_lshl_add_u32 v22, v2, 4, v22
    v_add_u32 v22, 151552, v22
LW9:
    ds_read_b32 v252, v250 offset:32
    s_waitcnt lgkmcnt(0)
    v_readfirstlane_b32 s79, v252
    s_cmp_lt_u32 s79, 4
    s_cbranch_scc1 LW9
    ds_read_b128 v[44:47], v22
    ds_read_b128 v[48:51], v22 offset:64
    s_waitcnt lgkmcnt(0)
    v_mfma_f32_16x16x32_bf16 v[96:99], v[128:131], v[44:47], 0
    v_mfma_f32_16x16x32_bf16 v[96:99], v[132:135], v[48:51], v[96:99]
    v_mfma_f32_16x16x32_bf16 v[100:103], v[136:139], v[44:47], 0
    v_mfma_f32_16x16x32_bf16 v[100:103], v[140:143], v[48:51], v[100:103]
    v_mfma_f32_16x16x32_bf16 v[104:107], v[144:147], v[44:47], 0
    v_mfma_f32_16x16x32_bf16 v[104:107], v[148:151], v[48:51], v[104:107]
    v_mfma_f32_16x16x32_bf16 v[108:111], v[152:155], v[44:47], 0
    v_mfma_f32_16x16x32_bf16 v[108:111], v[156:159], v[48:51], v[108:111]
    v_mfma_f32_16x16x32_bf16 v[112:115], v[160:163], v[44:47], 0
    v_mfma_f32_16x16x32_bf16 v[112:115], v[164:167], v[48:51], v[112:115]
    v_mfma_f32_16x16x32_bf16 v[116:119], v[168:171], v[44:47], 0
    v_mfma_f32_16x16x32_bf16 v[116:119], v[172:175], v[48:51], v[116:119]
    v_mfma_f32_16x16x32_bf16 v[120:123], v[176:179], v[44:47], 0
    v_mfma_f32_16x16x32_bf16 v[120:123], v[180:183], v[48:51], v[120:123]
    v_mfma_f32_16x16x32_bf16 v[124:127], v[184:187], v[44:47], 0
    v_mfma_f32_16x16x32_bf16 v[124:127], v[188:191], v[48:51], v[124:127]
    s_nop 7
    v_cvt_pk_bf16_f32 v44, v96, v97
    v_cvt_pk_bf16_f32 v45, v98, v99
    v_cvt_pk_bf16_f32 v46, v100, v101
    v_cvt_pk_bf16_f32 v47, v102, v103
    v_cvt_pk_bf16_f32 v48, v104, v105
    v_cvt_pk_bf16_f32 v49, v106, v107
    v_cvt_pk_bf16_f32 v50, v108, v109
    v_cvt_pk_bf16_f32 v51, v110, v111
    v_cvt_pk_bf16_f32 v52, v112, v113
    v_cvt_pk_bf16_f32 v53, v114, v115
    v_cvt_pk_bf16_f32 v54, v116, v117
    v_cvt_pk_bf16_f32 v55, v118, v119
    v_cvt_pk_bf16_f32 v56, v120, v121
    v_cvt_pk_bf16_f32 v57, v122, v123
    v_cvt_pk_bf16_f32 v58, v124, v125
    v_cvt_pk_bf16_f32 v59, v126, v127
    ds_read_b64_tr_b16 v[64:65], v18 offset:0
    ds_read_b64_tr_b16 v[66:67], v18 offset:16896
    ds_read_b64_tr_b16 v[68:69], v18 offset:33792
    ds_read_b64_tr_b16 v[70:71], v18 offset:50688
    ds_read_b64_tr_b16 v[72:73], v19 offset:0
    ds_read_b64_tr_b16 v[74:75], v19 offset:16896
    ds_read_b64_tr_b16 v[76:77], v19 offset:33792
    ds_read_b64_tr_b16 v[78:79], v19 offset:50688
    ds_read_b64_tr_b16 v[80:81], v18 offset:32
    ds_read_b64_tr_b16 v[82:83], v18 offset:16928
    ds_read_b64_tr_b16 v[84:85], v18 offset:33824
    ds_read_b64_tr_b16 v[86:87], v18 offset:50720
    ds_read_b64_tr_b16 v[88:89], v19 offset:32
    ds_read_b64_tr_b16 v[90:91], v19 offset:16928
    ds_read_b64_tr_b16 v[92:93], v19 offset:33824
    ds_read_b64_tr_b16 v[94:95], v19 offset:50720
    s_waitcnt lgkmcnt(8)
    v_mfma_f32_16x16x32_bf16 v[192:195], v[64:67], v[44:47], 0
    v_mfma_f32_16x16x32_bf16 v[192:195], v[68:71], v[48:51], v[192:195]
    v_mfma_f32_16x16x32_bf16 v[192:195], v[72:75], v[52:55], v[192:195]
    v_mfma_f32_16x16x32_bf16 v[192:195], v[76:79], v[56:59], v[192:195]
    ds_read_b64_tr_b16 v[64:65], v18 offset:64
    ds_read_b64_tr_b16 v[66:67], v18 offset:16960
    ds_read_b64_tr_b16 v[68:69], v18 offset:33856
    ds_read_b64_tr_b16 v[70:71], v18 offset:50752
    ds_read_b64_tr_b16 v[72:73], v19 offset:64
    ds_read_b64_tr_b16 v[74:75], v19 offset:16960
    ds_read_b64_tr_b16 v[76:77], v19 offset:33856
    ds_read_b64_tr_b16 v[78:79], v19 offset:50752
    s_waitcnt lgkmcnt(8)
    v_mfma_f32_16x16x32_bf16 v[196:199], v[80:83], v[44:47], 0
    v_mfma_f32_16x16x32_bf16 v[196:199], v[84:87], v[48:51], v[196:199]
    v_mfma_f32_16x16x32_bf16 v[196:199], v[88:91], v[52:55], v[196:199]
    v_mfma_f32_16x16x32_bf16 v[196:199], v[92:95], v[56:59], v[196:199]
    ds_read_b64_tr_b16 v[80:81], v18 offset:96
    ds_read_b64_tr_b16 v[82:83], v18 offset:16992
    ds_read_b64_tr_b16 v[84:85], v18 offset:33888
    ds_read_b64_tr_b16 v[86:87], v18 offset:50784
    ds_read_b64_tr_b16 v[88:89], v19 offset:96
    ds_read_b64_tr_b16 v[90:91], v19 offset:16992
    ds_read_b64_tr_b16 v[92:93], v19 offset:33888
    ds_read_b64_tr_b16 v[94:95], v19 offset:50784
    s_waitcnt lgkmcnt(8)
    v_mfma_f32_16x16x32_bf16 v[200:203], v[64:67], v[44:47], 0
    v_mfma_f32_16x16x32_bf16 v[200:203], v[68:71], v[48:51], v[200:203]
    v_mfma_f32_16x16x32_bf16 v[200:203], v[72:75], v[52:55], v[200:203]
    v_mfma_f32_16x16x32_bf16 v[200:203], v[76:79], v[56:59], v[200:203]
    ds_read_b64_tr_b16 v[64:65], v18 offset:128
    ds_read_b64_tr_b16 v[66:67], v18 offset:17024
    ds_read_b64_tr_b16 v[68:69], v18 offset:33920
    ds_read_b64_tr_b16 v[70:71], v18 offset:50816
    ds_read_b64_tr_b16 v[72:73], v19 offset:128
    ds_read_b64_tr_b16 v[74:75], v19 offset:17024
    ds_read_b64_tr_b16 v[76:77], v19 offset:33920
    ds_read_b64_tr_b16 v[78:79], v19 offset:50816
    s_waitcnt lgkmcnt(8)
    v_mfma_f32_16x16x32_bf16 v[204:207], v[80:83], v[44:47], 0
    v_mfma_f32_16x16x32_bf16 v[204:207], v[84:87], v[48:51], v[204:207]
    v_mfma_f32_16x16x32_bf16 v[204:207], v[88:91], v[52:55], v[204:207]
    v_mfma_f32_16x16x32_bf16 v[204:207], v[92:95], v[56:59], v[204:207]
    ds_read_b64_tr_b16 v[80:81], v18 offset:160
    ds_read_b64_tr_b16 v[82:83], v18 offset:17056
    ds_read_b64_tr_b16 v[84:85], v18 offset:33952
    ds_read_b64_tr_b16 v[86:87], v18 offset:50848
    ds_read_b64_tr_b16 v[88:89], v19 offset:160
    ds_read_b64_tr_b16 v[90:91], v19 offset:17056
    ds_read_b64_tr_b16 v[92:93], v19 offset:33952
    ds_read_b64_tr_b16 v[94:95], v19 offset:50848
    s_waitcnt lgkmcnt(8)
    v_mfma_f32_16x16x32_bf16 v[208:211], v[64:67], v[44:47], 0
    v_mfma_f32_16x16x32_bf16 v[208:211], v[68:71], v[48:51], v[208:211]
    v_mfma_f32_16x16x32_bf16 v[208:211], v[72:75], v[52:55], v[208:211]
    v_mfma_f32_16x16x32_bf16 v[208:211], v[76:79], v[56:59], v[208:211]
    ds_read_b64_tr_b16 v[64:65], v18 offset:192
    ds_read_b64_tr_b16 v[66:67], v18 offset:17088
    ds_read_b64_tr_b16 v[68:69], v18 offset:33984
    ds_read_b64_tr_b16 v[70:71], v18 offset:50880
    ds_read_b64_tr_b16 v[72:73], v19 offset:192
    ds_read_b64_tr_b16 v[74:75], v19 offset:17088
    ds_read_b64_tr_b16 v[76:77], v19 offset:33984
    ds_read_b64_tr_b16 v[78:79], v19 offset:50880
    s_waitcnt lgkmcnt(8)
    v_mfma_f32_16x16x32_bf16 v[212:215], v[80:83], v[44:47], 0
    v_mfma_f32_16x16x32_bf16 v[212:215], v[84:87], v[48:51], v[212:215]
    v_mfma_f32_16x16x32_bf16 v[212:215], v[88:91], v[52:55], v[212:215]
    v_mfma_f32_16x16x32_bf16 v[212:215], v[92:95], v[56:59], v[212:215]
    ds_read_b64_tr_b16 v[80:81], v18 offset:224
    ds_read_b64_tr_b16 v[82:83], v18 offset:17120
    ds_read_b64_tr_b16 v[84:85], v18 offset:34016
    ds_read_b64_tr_b16 v[86:87], v18 offset:50912
    ds_read_b64_tr_b16 v[88:89], v19 offset:224
    ds_read_b64_tr_b16 v[90:91], v19 offset:17120
    ds_read_b64_tr_b16 v[92:93], v19 offset:34016
    ds_read_b64_tr_b16 v[94:95], v19 offset:50912
    s_waitcnt lgkmcnt(8)
    v_mfma_f32_16x16x32_bf16 v[216:219], v[64:67], v[44:47], 0
    v_mfma_f32_16x16x32_bf16 v[216:219], v[68:71], v[48:51], v[216:219]
    v_mfma_f32_16x16x32_bf16 v[216:219], v[72:75], v[52:55], v[216:219]
    v_mfma_f32_16x16x32_bf16 v[216:219], v[76:79], v[56:59], v[216:219]
    s_waitcnt lgkmcnt(0)
    v_mfma_f32_16x16x32_bf16 v[220:223], v[80:83], v[44:47], 0
    v_mfma_f32_16x16x32_bf16 v[220:223], v[84:87], v[48:51], v[220:223]
    v_mfma_f32_16x16x32_bf16 v[220:223], v[88:91], v[52:55], v[220:223]
    v_mfma_f32_16x16x32_bf16 v[220:223], v[92:95], v[56:59], v[220:223]
    s_lshl_b32 s4, s2, 13
    s_lshl_b32 s5, s3, 9
    s_add_u32 s4, s4, s5
    s_add_u32 s6, s4, 6291456
    s_nop 7
    v_cmp_gt_u32 vcc, 4, v3
    s_and_saveexec_b64 s[10:11], vcc
    buffer_store_dwordx4 v[192:195], v36, s[64:67], s6 offen offset:0 sc1
    buffer_store_dwordx4 v[196:199], v36, s[64:67], s6 offen offset:64 sc1
    buffer_store_dwordx4 v[200:203], v36, s[64:67], s6 offen offset:128 sc1
    buffer_store_dwordx4 v[204:207], v36, s[64:67], s6 offen offset:192 sc1
    buffer_store_dwordx4 v[208:211], v36, s[64:67], s6 offen offset:256 sc1
    buffer_store_dwordx4 v[212:215], v36, s[64:67], s6 offen offset:320 sc1
    buffer_store_dwordx4 v[216:219], v36, s[64:67], s6 offen offset:384 sc1
    buffer_store_dwordx4 v[220:223], v36, s[64:67], s6 offen offset:448 sc1
    s_mov_b64 exec, s[10:11]
    v_mov_b32 v8, 0
    v_lshlrev_b32 v9, 16, v236
    v_lshlrev_b32 v10, 16, v240
    v_fmac_f32 v8, v9, v10
    v_and_b32 v9, 0xffff0000, v236
    v_and_b32 v10, 0xffff0000, v240
    v_fmac_f32 v8, v9, v10
    v_lshlrev_b32 v9, 16, v237
    v_lshlrev_b32 v10, 16, v241
    v_fmac_f32 v8, v9, v10
    v_and_b32 v9, 0xffff0000, v237
    v_and_b32 v10, 0xffff0000, v241
    v_fmac_f32 v8, v9, v10
    v_lshlrev_b32 v9, 16, v238
    v_lshlrev_b32 v10, 16, v242
    v_fmac_f32 v8, v9, v10
    v_and_b32 v9, 0xffff0000, v238
    v_and_b32 v10, 0xffff0000, v242
    v_fmac_f32 v8, v9, v10
    v_lshlrev_b32 v9, 16, v239
    v_lshlrev_b32 v10, 16, v243
    v_fmac_f32 v8, v9, v10
    v_and_b32 v9, 0xffff0000, v239
    v_and_b32 v10, 0xffff0000, v243
    v_fmac_f32 v8, v9, v10
    s_nop 1
    v_add_f32_dpp v8, v8, v8 row_shr:1 row_mask:0xf bank_mask:0xf
    s_nop 1
    v_add_f32_dpp v8, v8, v8 row_shr:2 row_mask:0xf bank_mask:0xf
    s_nop 1
    v_add_f32_dpp v8, v8, v8 row_shr:4 row_mask:0xf bank_mask:0xf
    s_nop 1
    v_add_f32_dpp v8, v8, v8 row_shr:8 row_mask:0xf bank_mask:0xf
    s_nop 1
    v_add_f32_dpp v8, v8, v8 row_bcast:15 row_mask:0xa bank_mask:0xf
    s_nop 1
    v_add_f32_dpp v8, v8, v8 row_bcast:31 row_mask:0xc bank_mask:0xf
    s_nop 1
    v_readlane_b32 s72, v8, 63
    s_nop 3
    v_mov_b32 v13, s72
    v_cvt_pk_bf16_f32 v12, v13, v13
    v_lshlrev_b32 v13, 16, v12
    v_mul_f32 v13, 0xbfb8aa3b, v13
    v_exp_f32 v13, v13
    s_nop 0
    v_add_f32 v13, 1.0, v13
    v_rcp_f32 v13, v13
    s_nop 0
    v_cvt_pk_bf16_f32 v12, v13, v13
    v_lshlrev_b32 v13, 16, v12
    v_lshlrev_b32 v245, 16, v245
    v_lshlrev_b32 v244, 16, v244
    s_waitcnt vmcnt(0)
    v_lshlrev_b32 v5, 12, v1
    v_mov_b32 v6, 1
    s_lshl_b32 s4, s2, 2
    s_lshl_b32 s5, s3, 10
    s_add_u32 s4, s4, s5
    s_add_u32 s4, s4, 10616832
    s_mov_b64 exec, 0xffffffff
    buffer_store_dword v6, v5, s[64:67], s4 offen sc1
    s_mov_b64 exec, -1
    s_add_u32 s4, s15, 10616832
    s_mov_b32 s82, 0
LC_pollC:
    s_sleep 1
    buffer_load_dword v6, v231, s[64:67], s4 offen sc1
    s_waitcnt vmcnt(0)
    v_cmp_ne_u32 vcc, 1, v6
    s_add_u32 s82, s82, 1
    s_cmp_gt_u32 s82, 200000
    s_cbranch_scc1 LC_pollC2
    s_cbranch_vccnz LC_pollC
LC_pollC2:
    s_add_u32 s5, s83, 6291456
    buffer_load_dword v16, v230, s[64:67], s5 offen sc1
    s_add_u32 s5, s5, 65536
    buffer_load_dword v17, v230, s[64:67], s5 offen sc1
    s_add_u32 s5, s5, 65536
    buffer_load_dword v18, v230, s[64:67], s5 offen sc1
    s_add_u32 s5, s5, 65536
    buffer_load_dword v19, v230, s[64:67], s5 offen sc1
    s_add_u32 s5, s5, 65536
    buffer_load_dword v20, v230, s[64:67], s5 offen sc1
    s_add_u32 s5, s5, 65536
    buffer_load_dword v21, v230, s[64:67], s5 offen sc1
    s_add_u32 s5, s5, 65536
    buffer_load_dword v22, v230, s[64:67], s5 offen sc1
    s_add_u32 s5, s5, 65536
    buffer_load_dword v23, v230, s[64:67], s5 offen sc1
    s_add_u32 s5, s5, 65536
    v_mov_b32 v24, v229
    s_waitcnt vmcnt(0)
    v_add_f32 v16, v16, v17
    v_add_f32 v16, v16, v18
    v_add_f32 v16, v16, v19
    v_add_f32 v16, v16, v20
    v_add_f32 v16, v16, v21
    v_add_f32 v16, v16, v22
    v_add_f32 v16, v16, v23
    ds_swizzle_b32 v17, v16 offset:8223
    ds_swizzle_b32 v25, v24 offset:8223
    s_waitcnt lgkmcnt(0)
    v_add_f32 v16, v16, v17
    v_add_f32 v24, v24, v25
    ds_swizzle_b32 v17, v16 offset:16415
    ds_swizzle_b32 v25, v24 offset:16415
    s_waitcnt lgkmcnt(0)
    v_add_f32 v16, v16, v17
    v_add_f32 v24, v24, v25
    v_mov_b32 v17, v16
    v_mov_b32 v25, v24
    s_nop 1
    v_permlane32_swap_b32 v16, v17
    v_permlane32_swap_b32 v24, v25
    s_nop 1
    v_add_f32 v16, v16, v17
    v_add_f32 v24, v24, v25
    v_and_b32 v11, 7, v1
    v_lshlrev_b32 v11, 2, v11
    v_add_u32 v11, 153600, v11
    s_lshl_b32 s4, s3, 6
    v_add_u32 v12, s4, v11
    ds_write_b32 v12, v16
    ds_write_b32 v12, v24 offset:32
    s_waitcnt lgkmcnt(0)
    s_mov_b64 exec, 1
    ds_add_u32 v250, v251 offset:40
    s_mov_b64 exec, -1
    s_cmp_lg_u32 s3, 0
    s_cbranch_scc1 L_done
LW10:
    ds_read_b32 v252, v250 offset:40
    s_waitcnt lgkmcnt(0)
    v_readfirstlane_b32 s79, v252
    s_cmp_lt_u32 s79, 4
    s_cbranch_scc1 LW10
    ds_read_b32 v64, v11 offset:0
    ds_read_b32 v96, v11 offset:32
    ds_read_b32 v65, v11 offset:64
    ds_read_b32 v97, v11 offset:96
    ds_read_b32 v66, v11 offset:128
    ds_read_b32 v98, v11 offset:160
    ds_read_b32 v67, v11 offset:192
    ds_read_b32 v99, v11 offset:224
    s_mov_b32 s48, s38
    s_and_b32 s49, s39, 0xffff
    s_mov_b32 s50, 0x1000
    s_mov_b32 s51, 0x00020000
    s_waitcnt lgkmcnt(0)
    v_add_f32 v64, v64, v65
    v_add_f32 v66, v66, v67
    v_add_f32 v64, v64, v66
    v_add_f32 v96, v96, v97
    v_add_f32 v98, v98, v99
    v_add_f32 v96, v96, v98
    v_cvt_pk_bf16_f32 v12, v64, v64
    v_lshlrev_b32 v64, 16, v12
    v_cvt_pk_bf16_f32 v12, v96, v96
    v_lshlrev_b32 v96, 16, v12
    v_mul_f32 v96, v96, v13
    v_cvt_pk_bf16_f32 v12, v96, v96
    v_lshlrev_b32 v96, 16, v12
    v_add_f32 v96, v245, v96
    v_cvt_pk_bf16_f32 v12, v96, v96
    v_lshlrev_b32 v96, 16, v12
    v_mul_f32 v14, 0xbfb8aa3b, v96
    v_exp_f32 v14, v14
    s_nop 0
    v_add_f32 v14, 1.0, v14
    v_rcp_f32 v14, v14
    s_nop 0
    v_mul_f32 v96, v96, v14
    v_cvt_pk_bf16_f32 v12, v96, v96
    v_lshlrev_b32 v96, 16, v12
    v_mul_f32 v64, v64, v96
    v_cvt_pk_bf16_f32 v12, v64, v64
    v_lshlrev_b32 v64, 16, v12
    v_add_f32 v64, v244, v64
    v_cvt_pk_bf16_f32 v64, v64, v64
    s_mov_b64 exec, 0xff
    buffer_store_short v64, v246, s[48:51], s78 offen
    s_branch L_done
L_loader:
    s_mov_b32 s44, s18
    s_and_b32 s45, s19, 0xffff
    s_mov_b32 s46, 0x1000000
    s_mov_b32 s47, 0x00020000
    s_lshl_b32 s7, s75, 22
    s_lshl_b32 s8, s76, 17
    s_add_u32 s7, s7, s8
    s_lshl_b32 s8, s3, 15
    s_add_u32 s7, s7, s8
    s_mul_i32 s8, s3, 33792
    s_mov_b32 m0, s8
    s_add_u32 s8, s8, 1056
    buffer_load_dwordx4 v4, s[44:47], s7 offen lds
    s_add_u32 s7, s7, 1024
    s_mov_b32 m0, s8
    s_add_u32 s8, s8, 1056
    buffer_load_dwordx4 v4, s[44:47], s7 offen lds
    s_add_u32 s7, s7, 1024
    s_mov_b32 m0, s8
    s_add_u32 s8, s8, 1056
    buffer_load_dwordx4 v4, s[44:47], s7 offen lds
    s_add_u32 s7, s7, 1024
    s_mov_b32 m0, s8
    s_add_u32 s8, s8, 1056
    buffer_load_dwordx4 v4, s[44:47], s7 offen lds
    s_add_u32 s7, s7, 1024
    s_mov_b32 m0, s8
    s_add_u32 s8, s8, 1056
    buffer_load_dwordx4 v4, s[44:47], s7 offen lds
    s_add_u32 s7, s7, 1024
    s_mov_b32 m0, s8
    s_add_u32 s8, s8, 1056
    buffer_load_dwordx4 v4, s[44:47], s7 offen lds
    s_add_u32 s7, s7, 1024
    s_mov_b32 m0, s8
    s_add_u32 s8, s8, 1056
    buffer_load_dwordx4 v4, s[44:47], s7 offen lds
    s_add_u32 s7, s7, 1024
    s_mov_b32 m0, s8
    s_add_u32 s8, s8, 1056
    buffer_load_dwordx4 v4, s[44:47], s7 offen lds
    s_add_u32 s7, s7, 1024
    s_mov_b32 m0, s8
    s_add_u32 s8, s8, 1056
    buffer_load_dwordx4 v4, s[44:47], s7 offen lds
    s_add_u32 s7, s7, 1024
    s_mov_b32 m0, s8
    s_add_u32 s8, s8, 1056
    buffer_load_dwordx4 v4, s[44:47], s7 offen lds
    s_add_u32 s7, s7, 1024
    s_mov_b32 m0, s8
    s_add_u32 s8, s8, 1056
    buffer_load_dwordx4 v4, s[44:47], s7 offen lds
    s_add_u32 s7, s7, 1024
    s_mov_b32 m0, s8
    s_add_u32 s8, s8, 1056
    buffer_load_dwordx4 v4, s[44:47], s7 offen lds
    s_add_u32 s7, s7, 1024
    s_mov_b32 m0, s8
    s_add_u32 s8, s8, 1056
    buffer_load_dwordx4 v4, s[44:47], s7 offen lds
    s_add_u32 s7, s7, 1024
    s_mov_b32 m0, s8
    s_add_u32 s8, s8, 1056
    buffer_load_dwordx4 v4, s[44:47], s7 offen lds
    s_add_u32 s7, s7, 1024
    s_mov_b32 m0, s8
    s_add_u32 s8, s8, 1056
    buffer_load_dwordx4 v4, s[44:47], s7 offen lds
    s_add_u32 s7, s7, 1024
    s_mov_b32 m0, s8
    s_add_u32 s8, s8, 1056
    buffer_load_dwordx4 v4, s[44:47], s7 offen lds
    s_add_u32 s7, s7, 1024
    s_mov_b32 m0, s8
    s_add_u32 s8, s8, 1056
    buffer_load_dwordx4 v4, s[44:47], s7 offen lds
    s_add_u32 s7, s7, 1024
    s_mov_b32 m0, s8
    s_add_u32 s8, s8, 1056
    buffer_load_dwordx4 v4, s[44:47], s7 offen lds
    s_add_u32 s7, s7, 1024
    s_mov_b32 m0, s8
    s_add_u32 s8, s8, 1056
    buffer_load_dwordx4 v4, s[44:47], s7 offen lds
    s_add_u32 s7, s7, 1024
    s_mov_b32 m0, s8
    s_add_u32 s8, s8, 1056
    buffer_load_dwordx4 v4, s[44:47], s7 offen lds
    s_add_u32 s7, s7, 1024
    s_mov_b32 m0, s8
    s_add_u32 s8, s8, 1056
    buffer_load_dwordx4 v4, s[44:47], s7 offen lds
    s_add_u32 s7, s7, 1024
    s_mov_b32 m0, s8
    s_add_u32 s8, s8, 1056
    buffer_load_dwordx4 v4, s[44:47], s7 offen lds
    s_add_u32 s7, s7, 1024
    s_mov_b32 m0, s8
    s_add_u32 s8, s8, 1056
    buffer_load_dwordx4 v4, s[44:47], s7 offen lds
    s_add_u32 s7, s7, 1024
    s_mov_b32 m0, s8
    s_add_u32 s8, s8, 1056
    buffer_load_dwordx4 v4, s[44:47], s7 offen lds
    s_add_u32 s7, s7, 1024
    s_mov_b32 m0, s8
    s_add_u32 s8, s8, 1056
    buffer_load_dwordx4 v4, s[44:47], s7 offen lds
    s_add_u32 s7, s7, 1024
    s_mov_b32 m0, s8
    s_add_u32 s8, s8, 1056
    buffer_load_dwordx4 v4, s[44:47], s7 offen lds
    s_add_u32 s7, s7, 1024
    s_mov_b32 m0, s8
    s_add_u32 s8, s8, 1056
    buffer_load_dwordx4 v4, s[44:47], s7 offen lds
    s_add_u32 s7, s7, 1024
    s_mov_b32 m0, s8
    s_add_u32 s8, s8, 1056
    buffer_load_dwordx4 v4, s[44:47], s7 offen lds
    s_add_u32 s7, s7, 1024
    s_mov_b32 m0, s8
    s_add_u32 s8, s8, 1056
    buffer_load_dwordx4 v4, s[44:47], s7 offen lds
    s_add_u32 s7, s7, 1024
    s_mov_b32 m0, s8
    s_add_u32 s8, s8, 1056
    buffer_load_dwordx4 v4, s[44:47], s7 offen lds
    s_add_u32 s7, s7, 1024
    s_mov_b32 m0, s8
    s_add_u32 s8, s8, 1056
    buffer_load_dwordx4 v4, s[44:47], s7 offen lds
    s_add_u32 s7, s7, 1024
    s_mov_b32 m0, s8
    s_add_u32 s8, s8, 1056
    buffer_load_dwordx4 v4, s[44:47], s7 offen lds
    s_add_u32 s7, s7, 1024
    s_and_b32 s5, s3, 1
    s_lshl_b32 s5, s5, 3
    v_lshlrev_b32 v5, 1, v2
    v_add_u32 v5, s5, v5
    v_xor_b32 v5, v5, v3
    v_lshlrev_b32 v5, 4, v5
    v_lshl_add_u32 v6, v2, 13, v5
    s_mov_b32 s48, s26
    s_and_b32 s49, s27, 0xffff
    s_mov_b32 s50, 0x400000
    s_mov_b32 s51, 0x00020000
    s_lshl_b32 s6, s68, 17
    s_lshl_b32 s7, s3, 15
    s_add_u32 s6, s6, s7
    s_waitcnt vmcnt(0)
    s_mov_b64 exec, 1
    ds_add_u32 v250, v251 offset:4
    s_mov_b64 exec, -1
    s_cmp_eq_u32 s69, 0
    s_cbranch_scc1 LL_wob0
    s_cmp_eq_u32 s69, 1
    s_cbranch_scc1 LL_wob1
    s_cmp_eq_u32 s69, 2
    s_cbranch_scc1 LL_wob2
    s_cmp_eq_u32 s69, 3
    s_cbranch_scc1 LL_wob3
    s_cmp_eq_u32 s69, 4
    s_cbranch_scc1 LL_wob4
    s_cmp_eq_u32 s69, 5
    s_cbranch_scc1 LL_wob5
    s_cmp_eq_u32 s69, 6
    s_cbranch_scc1 LL_wob6
    s_cmp_eq_u32 s69, 7
    s_cbranch_scc1 LL_wob7
LL_wob0:
    s_add_u32 s7, s6, 0
    buffer_load_dwordx4 v[64:67], v4, s[48:51], s7 offen
    s_add_u32 s7, s6, 1024
    buffer_load_dwordx4 v[68:71], v4, s[48:51], s7 offen
    s_add_u32 s7, s6, 2048
    buffer_load_dwordx4 v[72:75], v4, s[48:51], s7 offen
    s_add_u32 s7, s6, 3072
    buffer_load_dwordx4 v[76:79], v4, s[48:51], s7 offen
    s_add_u32 s7, s6, 4096
    buffer_load_dwordx4 v[80:83], v4, s[48:51], s7 offen
    s_add_u32 s7, s6, 5120
    buffer_load_dwordx4 v[84:87], v4, s[48:51], s7 offen
    s_add_u32 s7, s6, 6144
    buffer_load_dwordx4 v[88:91], v4, s[48:51], s7 offen
    s_add_u32 s7, s6, 7168
    buffer_load_dwordx4 v[92:95], v4, s[48:51], s7 offen
    s_add_u32 s7, s6, 8192
    buffer_load_dwordx4 v[96:99], v4, s[48:51], s7 offen
    s_add_u32 s7, s6, 9216
    buffer_load_dwordx4 v[100:103], v4, s[48:51], s7 offen
    s_add_u32 s7, s6, 10240
    buffer_load_dwordx4 v[104:107], v4, s[48:51], s7 offen
    s_add_u32 s7, s6, 11264
    buffer_load_dwordx4 v[108:111], v4, s[48:51], s7 offen
    s_add_u32 s7, s6, 12288
    buffer_load_dwordx4 v[112:115], v4, s[48:51], s7 offen
    s_add_u32 s7, s6, 13312
    buffer_load_dwordx4 v[116:119], v4, s[48:51], s7 offen
    s_add_u32 s7, s6, 14336
    buffer_load_dwordx4 v[120:123], v4, s[48:51], s7 offen
    s_add_u32 s7, s6, 15360
    buffer_load_dwordx4 v[124:127], v4, s[48:51], s7 offen
    s_add_u32 s7, s6, 16384
    buffer_load_dwordx4 v[128:131], v4, s[48:51], s7 offen
    s_add_u32 s7, s6, 17408
    buffer_load_dwordx4 v[132:135], v4, s[48:51], s7 offen
    s_add_u32 s7, s6, 18432
    buffer_load_dwordx4 v[136:139], v4, s[48:51], s7 offen
    s_add_u32 s7, s6, 19456
    buffer_load_dwordx4 v[140:143], v4, s[48:51], s7 offen
    s_add_u32 s7, s6, 20480
    buffer_load_dwordx4 v[144:147], v4, s[48:51], s7 offen
    s_add_u32 s7, s6, 21504
    buffer_load_dwordx4 v[148:151], v4, s[48:51], s7 offen
    s_add_u32 s7, s6, 22528
    buffer_load_dwordx4 v[152:155], v4, s[48:51], s7 offen
    s_add_u32 s7, s6, 23552
    buffer_load_dwordx4 v[156:159], v4, s[48:51], s7 offen
    s_add_u32 s7, s6, 24576
    buffer_load_dwordx4 v[160:163], v4, s[48:51], s7 offen
    s_add_u32 s7, s6, 25600
    buffer_load_dwordx4 v[164:167], v4, s[48:51], s7 offen
    s_add_u32 s7, s6, 26624
    buffer_load_dwordx4 v[168:171], v4, s[48:51], s7 offen
    s_add_u32 s7, s6, 27648
    buffer_load_dwordx4 v[172:175], v4, s[48:51], s7 offen
    s_add_u32 s7, s6, 28672
    buffer_load_dwordx4 v[176:179], v4, s[48:51], s7 offen
    s_add_u32 s7, s6, 29696
    buffer_load_dwordx4 v[180:183], v4, s[48:51], s7 offen
    s_add_u32 s7, s6, 30720
    buffer_load_dwordx4 v[184:187], v4, s[48:51], s7 offen
    s_add_u32 s7, s6, 31744
    buffer_load_dwordx4 v[188:191], v4, s[48:51], s7 offen
    s_branch LL_wodb
LL_wob1:
    s_add_u32 s7, s6, 4096
    buffer_load_dwordx4 v[80:83], v4, s[48:51], s7 offen
    s_add_u32 s7, s6, 5120
    buffer_load_dwordx4 v[84:87], v4, s[48:51], s7 offen
    s_add_u32 s7, s6, 6144
    buffer_load_dwordx4 v[88:91], v4, s[48:51], s7 offen
    s_add_u32 s7, s6, 7168
    buffer_load_dwordx4 v[92:95], v4, s[48:51], s7 offen
    s_add_u32 s7, s6, 8192
    buffer_load_dwordx4 v[96:99], v4, s[48:51], s7 offen
    s_add_u32 s7, s6, 9216
    buffer_load_dwordx4 v[100:103], v4, s[48:51], s7 offen
    s_add_u32 s7, s6, 10240
    buffer_load_dwordx4 v[104:107], v4, s[48:51], s7 offen
    s_add_u32 s7, s6, 11264
    buffer_load_dwordx4 v[108:111], v4, s[48:51], s7 offen
    s_add_u32 s7, s6, 12288
    buffer_load_dwordx4 v[112:115], v4, s[48:51], s7 offen
    s_add_u32 s7, s6, 13312
    buffer_load_dwordx4 v[116:119], v4, s[48:51], s7 offen
    s_add_u32 s7, s6, 14336
    buffer_load_dwordx4 v[120:123], v4, s[48:51], s7 offen
    s_add_u32 s7, s6, 15360
    buffer_load_dwordx4 v[124:127], v4, s[48:51], s7 offen
    s_add_u32 s7, s6, 16384
    buffer_load_dwordx4 v[128:131], v4, s[48:51], s7 offen
    s_add_u32 s7, s6, 17408
    buffer_load_dwordx4 v[132:135], v4, s[48:51], s7 offen
    s_add_u32 s7, s6, 18432
    buffer_load_dwordx4 v[136:139], v4, s[48:51], s7 offen
    s_add_u32 s7, s6, 19456
    buffer_load_dwordx4 v[140:143], v4, s[48:51], s7 offen
    s_add_u32 s7, s6, 20480
    buffer_load_dwordx4 v[144:147], v4, s[48:51], s7 offen
    s_add_u32 s7, s6, 21504
    buffer_load_dwordx4 v[148:151], v4, s[48:51], s7 offen
    s_add_u32 s7, s6, 22528
    buffer_load_dwordx4 v[152:155], v4, s[48:51], s7 offen
    s_add_u32 s7, s6, 23552
    buffer_load_dwordx4 v[156:159], v4, s[48:51], s7 offen
    s_add_u32 s7, s6, 24576
    buffer_load_dwordx4 v[160:163], v4, s[48:51], s7 offen
    s_add_u32 s7, s6, 25600
    buffer_load_dwordx4 v[164:167], v4, s[48:51], s7 offen
    s_add_u32 s7, s6, 26624
    buffer_load_dwordx4 v[168:171], v4, s[48:51], s7 offen
    s_add_u32 s7, s6, 27648
    buffer_load_dwordx4 v[172:175], v4, s[48:51], s7 offen
    s_add_u32 s7, s6, 28672
    buffer_load_dwordx4 v[176:179], v4, s[48:51], s7 offen
    s_add_u32 s7, s6, 29696
    buffer_load_dwordx4 v[180:183], v4, s[48:51], s7 offen
    s_add_u32 s7, s6, 30720
    buffer_load_dwordx4 v[184:187], v4, s[48:51], s7 offen
    s_add_u32 s7, s6, 31744
    buffer_load_dwordx4 v[188:191], v4, s[48:51], s7 offen
    s_add_u32 s7, s6, 0
    buffer_load_dwordx4 v[64:67], v4, s[48:51], s7 offen
    s_add_u32 s7, s6, 1024
    buffer_load_dwordx4 v[68:71], v4, s[48:51], s7 offen
    s_add_u32 s7, s6, 2048
    buffer_load_dwordx4 v[72:75], v4, s[48:51], s7 offen
    s_add_u32 s7, s6, 3072
    buffer_load_dwordx4 v[76:79], v4, s[48:51], s7 offen
    s_branch LL_wodb
LL_wob2:
    s_add_u32 s7, s6, 8192
    buffer_load_dwordx4 v[96:99], v4, s[48:51], s7 offen
    s_add_u32 s7, s6, 9216
    buffer_load_dwordx4 v[100:103], v4, s[48:51], s7 offen
    s_add_u32 s7, s6, 10240
    buffer_load_dwordx4 v[104:107], v4, s[48:51], s7 offen
    s_add_u32 s7, s6, 11264
    buffer_load_dwordx4 v[108:111], v4, s[48:51], s7 offen
    s_add_u32 s7, s6, 12288
    buffer_load_dwordx4 v[112:115], v4, s[48:51], s7 offen
    s_add_u32 s7, s6, 13312
    buffer_load_dwordx4 v[116:119], v4, s[48:51], s7 offen
    s_add_u32 s7, s6, 14336
    buffer_load_dwordx4 v[120:123], v4, s[48:51], s7 offen
    s_add_u32 s7, s6, 15360
    buffer_load_dwordx4 v[124:127], v4, s[48:51], s7 offen
    s_add_u32 s7, s6, 16384
    buffer_load_dwordx4 v[128:131], v4, s[48:51], s7 offen
    s_add_u32 s7, s6, 17408
    buffer_load_dwordx4 v[132:135], v4, s[48:51], s7 offen
    s_add_u32 s7, s6, 18432
    buffer_load_dwordx4 v[136:139], v4, s[48:51], s7 offen
    s_add_u32 s7, s6, 19456
    buffer_load_dwordx4 v[140:143], v4, s[48:51], s7 offen
    s_add_u32 s7, s6, 20480
    buffer_load_dwordx4 v[144:147], v4, s[48:51], s7 offen
    s_add_u32 s7, s6, 21504
    buffer_load_dwordx4 v[148:151], v4, s[48:51], s7 offen
    s_add_u32 s7, s6, 22528
    buffer_load_dwordx4 v[152:155], v4, s[48:51], s7 offen
    s_add_u32 s7, s6, 23552
    buffer_load_dwordx4 v[156:159], v4, s[48:51], s7 offen
    s_add_u32 s7, s6, 24576
    buffer_load_dwordx4 v[160:163], v4, s[48:51], s7 offen
    s_add_u32 s7, s6, 25600
    buffer_load_dwordx4 v[164:167], v4, s[48:51], s7 offen
    s_add_u32 s7, s6, 26624
    buffer_load_dwordx4 v[168:171], v4, s[48:51], s7 offen
    s_add_u32 s7, s6, 27648
    buffer_load_dwordx4 v[172:175], v4, s[48:51], s7 offen
    s_add_u32 s7, s6, 28672
    buffer_load_dwordx4 v[176:179], v4, s[48:51], s7 offen
    s_add_u32 s7, s6, 29696
    buffer_load_dwordx4 v[180:183], v4, s[48:51], s7 offen
    s_add_u32 s7, s6, 30720
    buffer_load_dwordx4 v[184:187], v4, s[48:51], s7 offen
    s_add_u32 s7, s6, 31744
    buffer_load_dwordx4 v[188:191], v4, s[48:51], s7 offen
    s_add_u32 s7, s6, 0
    buffer_load_dwordx4 v[64:67], v4, s[48:51], s7 offen
    s_add_u32 s7, s6, 1024
    buffer_load_dwordx4 v[68:71], v4, s[48:51], s7 offen
    s_add_u32 s7, s6, 2048
    buffer_load_dwordx4 v[72:75], v4, s[48:51], s7 offen
    s_add_u32 s7, s6, 3072
    buffer_load_dwordx4 v[76:79], v4, s[48:51], s7 offen
    s_add_u32 s7, s6, 4096
    buffer_load_dwordx4 v[80:83], v4, s[48:51], s7 offen
    s_add_u32 s7, s6, 5120
    buffer_load_dwordx4 v[84:87], v4, s[48:51], s7 offen
    s_add_u32 s7, s6, 6144
    buffer_load_dwordx4 v[88:91], v4, s[48:51], s7 offen
    s_add_u32 s7, s6, 7168
    buffer_load_dwordx4 v[92:95], v4, s[48:51], s7 offen
    s_branch LL_wodb
LL_wob3:
    s_add_u32 s7, s6, 12288
    buffer_load_dwordx4 v[112:115], v4, s[48:51], s7 offen
    s_add_u32 s7, s6, 13312
    buffer_load_dwordx4 v[116:119], v4, s[48:51], s7 offen
    s_add_u32 s7, s6, 14336
    buffer_load_dwordx4 v[120:123], v4, s[48:51], s7 offen
    s_add_u32 s7, s6, 15360
    buffer_load_dwordx4 v[124:127], v4, s[48:51], s7 offen
    s_add_u32 s7, s6, 16384
    buffer_load_dwordx4 v[128:131], v4, s[48:51], s7 offen
    s_add_u32 s7, s6, 17408
    buffer_load_dwordx4 v[132:135], v4, s[48:51], s7 offen
    s_add_u32 s7, s6, 18432
    buffer_load_dwordx4 v[136:139], v4, s[48:51], s7 offen
    s_add_u32 s7, s6, 19456
    buffer_load_dwordx4 v[140:143], v4, s[48:51], s7 offen
    s_add_u32 s7, s6, 20480
    buffer_load_dwordx4 v[144:147], v4, s[48:51], s7 offen
    s_add_u32 s7, s6, 21504
    buffer_load_dwordx4 v[148:151], v4, s[48:51], s7 offen
    s_add_u32 s7, s6, 22528
    buffer_load_dwordx4 v[152:155], v4, s[48:51], s7 offen
    s_add_u32 s7, s6, 23552
    buffer_load_dwordx4 v[156:159], v4, s[48:51], s7 offen
    s_add_u32 s7, s6, 24576
    buffer_load_dwordx4 v[160:163], v4, s[48:51], s7 offen
    s_add_u32 s7, s6, 25600
    buffer_load_dwordx4 v[164:167], v4, s[48:51], s7 offen
    s_add_u32 s7, s6, 26624
    buffer_load_dwordx4 v[168:171], v4, s[48:51], s7 offen
    s_add_u32 s7, s6, 27648
    buffer_load_dwordx4 v[172:175], v4, s[48:51], s7 offen
    s_add_u32 s7, s6, 28672
    buffer_load_dwordx4 v[176:179], v4, s[48:51], s7 offen
    s_add_u32 s7, s6, 29696
    buffer_load_dwordx4 v[180:183], v4, s[48:51], s7 offen
    s_add_u32 s7, s6, 30720
    buffer_load_dwordx4 v[184:187], v4, s[48:51], s7 offen
    s_add_u32 s7, s6, 31744
    buffer_load_dwordx4 v[188:191], v4, s[48:51], s7 offen
    s_add_u32 s7, s6, 0
    buffer_load_dwordx4 v[64:67], v4, s[48:51], s7 offen
    s_add_u32 s7, s6, 1024
    buffer_load_dwordx4 v[68:71], v4, s[48:51], s7 offen
    s_add_u32 s7, s6, 2048
    buffer_load_dwordx4 v[72:75], v4, s[48:51], s7 offen
    s_add_u32 s7, s6, 3072
    buffer_load_dwordx4 v[76:79], v4, s[48:51], s7 offen
    s_add_u32 s7, s6, 4096
    buffer_load_dwordx4 v[80:83], v4, s[48:51], s7 offen
    s_add_u32 s7, s6, 5120
    buffer_load_dwordx4 v[84:87], v4, s[48:51], s7 offen
    s_add_u32 s7, s6, 6144
    buffer_load_dwordx4 v[88:91], v4, s[48:51], s7 offen
    s_add_u32 s7, s6, 7168
    buffer_load_dwordx4 v[92:95], v4, s[48:51], s7 offen
    s_add_u32 s7, s6, 8192
    buffer_load_dwordx4 v[96:99], v4, s[48:51], s7 offen
    s_add_u32 s7, s6, 9216
    buffer_load_dwordx4 v[100:103], v4, s[48:51], s7 offen
    s_add_u32 s7, s6, 10240
    buffer_load_dwordx4 v[104:107], v4, s[48:51], s7 offen
    s_add_u32 s7, s6, 11264
    buffer_load_dwordx4 v[108:111], v4, s[48:51], s7 offen
    s_branch LL_wodb
LL_wob4:
    s_add_u32 s7, s6, 16384
    buffer_load_dwordx4 v[128:131], v4, s[48:51], s7 offen
    s_add_u32 s7, s6, 17408
    buffer_load_dwordx4 v[132:135], v4, s[48:51], s7 offen
    s_add_u32 s7, s6, 18432
    buffer_load_dwordx4 v[136:139], v4, s[48:51], s7 offen
    s_add_u32 s7, s6, 19456
    buffer_load_dwordx4 v[140:143], v4, s[48:51], s7 offen
    s_add_u32 s7, s6, 20480
    buffer_load_dwordx4 v[144:147], v4, s[48:51], s7 offen
    s_add_u32 s7, s6, 21504
    buffer_load_dwordx4 v[148:151], v4, s[48:51], s7 offen
    s_add_u32 s7, s6, 22528
    buffer_load_dwordx4 v[152:155], v4, s[48:51], s7 offen
    s_add_u32 s7, s6, 23552
    buffer_load_dwordx4 v[156:159], v4, s[48:51], s7 offen
    s_add_u32 s7, s6, 24576
    buffer_load_dwordx4 v[160:163], v4, s[48:51], s7 offen
    s_add_u32 s7, s6, 25600
    buffer_load_dwordx4 v[164:167], v4, s[48:51], s7 offen
    s_add_u32 s7, s6, 26624
    buffer_load_dwordx4 v[168:171], v4, s[48:51], s7 offen
    s_add_u32 s7, s6, 27648
    buffer_load_dwordx4 v[172:175], v4, s[48:51], s7 offen
    s_add_u32 s7, s6, 28672
    buffer_load_dwordx4 v[176:179], v4, s[48:51], s7 offen
    s_add_u32 s7, s6, 29696
    buffer_load_dwordx4 v[180:183], v4, s[48:51], s7 offen
    s_add_u32 s7, s6, 30720
    buffer_load_dwordx4 v[184:187], v4, s[48:51], s7 offen
    s_add_u32 s7, s6, 31744
    buffer_load_dwordx4 v[188:191], v4, s[48:51], s7 offen
    s_add_u32 s7, s6, 0
    buffer_load_dwordx4 v[64:67], v4, s[48:51], s7 offen
    s_add_u32 s7, s6, 1024
    buffer_load_dwordx4 v[68:71], v4, s[48:51], s7 offen
    s_add_u32 s7, s6, 2048
    buffer_load_dwordx4 v[72:75], v4, s[48:51], s7 offen
    s_add_u32 s7, s6, 3072
    buffer_load_dwordx4 v[76:79], v4, s[48:51], s7 offen
    s_add_u32 s7, s6, 4096
    buffer_load_dwordx4 v[80:83], v4, s[48:51], s7 offen
    s_add_u32 s7, s6, 5120
    buffer_load_dwordx4 v[84:87], v4, s[48:51], s7 offen
    s_add_u32 s7, s6, 6144
    buffer_load_dwordx4 v[88:91], v4, s[48:51], s7 offen
    s_add_u32 s7, s6, 7168
    buffer_load_dwordx4 v[92:95], v4, s[48:51], s7 offen
    s_add_u32 s7, s6, 8192
    buffer_load_dwordx4 v[96:99], v4, s[48:51], s7 offen
    s_add_u32 s7, s6, 9216
    buffer_load_dwordx4 v[100:103], v4, s[48:51], s7 offen
    s_add_u32 s7, s6, 10240
    buffer_load_dwordx4 v[104:107], v4, s[48:51], s7 offen
    s_add_u32 s7, s6, 11264
    buffer_load_dwordx4 v[108:111], v4, s[48:51], s7 offen
    s_add_u32 s7, s6, 12288
    buffer_load_dwordx4 v[112:115], v4, s[48:51], s7 offen
    s_add_u32 s7, s6, 13312
    buffer_load_dwordx4 v[116:119], v4, s[48:51], s7 offen
    s_add_u32 s7, s6, 14336
    buffer_load_dwordx4 v[120:123], v4, s[48:51], s7 offen
    s_add_u32 s7, s6, 15360
    buffer_load_dwordx4 v[124:127], v4, s[48:51], s7 offen
    s_branch LL_wodb
LL_wob5:
    s_add_u32 s7, s6, 20480
    buffer_load_dwordx4 v[144:147], v4, s[48:51], s7 offen
    s_add_u32 s7, s6, 21504
    buffer_load_dwordx4 v[148:151], v4, s[48:51], s7 offen
    s_add_u32 s7, s6, 22528
    buffer_load_dwordx4 v[152:155], v4, s[48:51], s7 offen
    s_add_u32 s7, s6, 23552
    buffer_load_dwordx4 v[156:159], v4, s[48:51], s7 offen
    s_add_u32 s7, s6, 24576
    buffer_load_dwordx4 v[160:163], v4, s[48:51], s7 offen
    s_add_u32 s7, s6, 25600
    buffer_load_dwordx4 v[164:167], v4, s[48:51], s7 offen
    s_add_u32 s7, s6, 26624
    buffer_load_dwordx4 v[168:171], v4, s[48:51], s7 offen
    s_add_u32 s7, s6, 27648
    buffer_load_dwordx4 v[172:175], v4, s[48:51], s7 offen
    s_add_u32 s7, s6, 28672
    buffer_load_dwordx4 v[176:179], v4, s[48:51], s7 offen
    s_add_u32 s7, s6, 29696
    buffer_load_dwordx4 v[180:183], v4, s[48:51], s7 offen
    s_add_u32 s7, s6, 30720
    buffer_load_dwordx4 v[184:187], v4, s[48:51], s7 offen
    s_add_u32 s7, s6, 31744
    buffer_load_dwordx4 v[188:191], v4, s[48:51], s7 offen
    s_add_u32 s7, s6, 0
    buffer_load_dwordx4 v[64:67], v4, s[48:51], s7 offen
    s_add_u32 s7, s6, 1024
    buffer_load_dwordx4 v[68:71], v4, s[48:51], s7 offen
    s_add_u32 s7, s6, 2048
    buffer_load_dwordx4 v[72:75], v4, s[48:51], s7 offen
    s_add_u32 s7, s6, 3072
    buffer_load_dwordx4 v[76:79], v4, s[48:51], s7 offen
    s_add_u32 s7, s6, 4096
    buffer_load_dwordx4 v[80:83], v4, s[48:51], s7 offen
    s_add_u32 s7, s6, 5120
    buffer_load_dwordx4 v[84:87], v4, s[48:51], s7 offen
    s_add_u32 s7, s6, 6144
    buffer_load_dwordx4 v[88:91], v4, s[48:51], s7 offen
    s_add_u32 s7, s6, 7168
    buffer_load_dwordx4 v[92:95], v4, s[48:51], s7 offen
    s_add_u32 s7, s6, 8192
    buffer_load_dwordx4 v[96:99], v4, s[48:51], s7 offen
    s_add_u32 s7, s6, 9216
    buffer_load_dwordx4 v[100:103], v4, s[48:51], s7 offen
    s_add_u32 s7, s6, 10240
    buffer_load_dwordx4 v[104:107], v4, s[48:51], s7 offen
    s_add_u32 s7, s6, 11264
    buffer_load_dwordx4 v[108:111], v4, s[48:51], s7 offen
    s_add_u32 s7, s6, 12288
    buffer_load_dwordx4 v[112:115], v4, s[48:51], s7 offen
    s_add_u32 s7, s6, 13312
    buffer_load_dwordx4 v[116:119], v4, s[48:51], s7 offen
    s_add_u32 s7, s6, 14336
    buffer_load_dwordx4 v[120:123], v4, s[48:51], s7 offen
    s_add_u32 s7, s6, 15360
    buffer_load_dwordx4 v[124:127], v4, s[48:51], s7 offen
    s_add_u32 s7, s6, 16384
    buffer_load_dwordx4 v[128:131], v4, s[48:51], s7 offen
    s_add_u32 s7, s6, 17408
    buffer_load_dwordx4 v[132:135], v4, s[48:51], s7 offen
    s_add_u32 s7, s6, 18432
    buffer_load_dwordx4 v[136:139], v4, s[48:51], s7 offen
    s_add_u32 s7, s6, 19456
    buffer_load_dwordx4 v[140:143], v4, s[48:51], s7 offen
    s_branch LL_wodb
LL_wob6:
    s_add_u32 s7, s6, 24576
    buffer_load_dwordx4 v[160:163], v4, s[48:51], s7 offen
    s_add_u32 s7, s6, 25600
    buffer_load_dwordx4 v[164:167], v4, s[48:51], s7 offen
    s_add_u32 s7, s6, 26624
    buffer_load_dwordx4 v[168:171], v4, s[48:51], s7 offen
    s_add_u32 s7, s6, 27648
    buffer_load_dwordx4 v[172:175], v4, s[48:51], s7 offen
    s_add_u32 s7, s6, 28672
    buffer_load_dwordx4 v[176:179], v4, s[48:51], s7 offen
    s_add_u32 s7, s6, 29696
    buffer_load_dwordx4 v[180:183], v4, s[48:51], s7 offen
    s_add_u32 s7, s6, 30720
    buffer_load_dwordx4 v[184:187], v4, s[48:51], s7 offen
    s_add_u32 s7, s6, 31744
    buffer_load_dwordx4 v[188:191], v4, s[48:51], s7 offen
    s_add_u32 s7, s6, 0
    buffer_load_dwordx4 v[64:67], v4, s[48:51], s7 offen
    s_add_u32 s7, s6, 1024
    buffer_load_dwordx4 v[68:71], v4, s[48:51], s7 offen
    s_add_u32 s7, s6, 2048
    buffer_load_dwordx4 v[72:75], v4, s[48:51], s7 offen
    s_add_u32 s7, s6, 3072
    buffer_load_dwordx4 v[76:79], v4, s[48:51], s7 offen
    s_add_u32 s7, s6, 4096
    buffer_load_dwordx4 v[80:83], v4, s[48:51], s7 offen
    s_add_u32 s7, s6, 5120
    buffer_load_dwordx4 v[84:87], v4, s[48:51], s7 offen
    s_add_u32 s7, s6, 6144
    buffer_load_dwordx4 v[88:91], v4, s[48:51], s7 offen
    s_add_u32 s7, s6, 7168
    buffer_load_dwordx4 v[92:95], v4, s[48:51], s7 offen
    s_add_u32 s7, s6, 8192
    buffer_load_dwordx4 v[96:99], v4, s[48:51], s7 offen
    s_add_u32 s7, s6, 9216
    buffer_load_dwordx4 v[100:103], v4, s[48:51], s7 offen
    s_add_u32 s7, s6, 10240
    buffer_load_dwordx4 v[104:107], v4, s[48:51], s7 offen
    s_add_u32 s7, s6, 11264
    buffer_load_dwordx4 v[108:111], v4, s[48:51], s7 offen
    s_add_u32 s7, s6, 12288
    buffer_load_dwordx4 v[112:115], v4, s[48:51], s7 offen
    s_add_u32 s7, s6, 13312
    buffer_load_dwordx4 v[116:119], v4, s[48:51], s7 offen
    s_add_u32 s7, s6, 14336
    buffer_load_dwordx4 v[120:123], v4, s[48:51], s7 offen
    s_add_u32 s7, s6, 15360
    buffer_load_dwordx4 v[124:127], v4, s[48:51], s7 offen
    s_add_u32 s7, s6, 16384
    buffer_load_dwordx4 v[128:131], v4, s[48:51], s7 offen
    s_add_u32 s7, s6, 17408
    buffer_load_dwordx4 v[132:135], v4, s[48:51], s7 offen
    s_add_u32 s7, s6, 18432
    buffer_load_dwordx4 v[136:139], v4, s[48:51], s7 offen
    s_add_u32 s7, s6, 19456
    buffer_load_dwordx4 v[140:143], v4, s[48:51], s7 offen
    s_add_u32 s7, s6, 20480
    buffer_load_dwordx4 v[144:147], v4, s[48:51], s7 offen
    s_add_u32 s7, s6, 21504
    buffer_load_dwordx4 v[148:151], v4, s[48:51], s7 offen
    s_add_u32 s7, s6, 22528
    buffer_load_dwordx4 v[152:155], v4, s[48:51], s7 offen
    s_add_u32 s7, s6, 23552
    buffer_load_dwordx4 v[156:159], v4, s[48:51], s7 offen
    s_branch LL_wodb
LL_wob7:
    s_add_u32 s7, s6, 28672
    buffer_load_dwordx4 v[176:179], v4, s[48:51], s7 offen
    s_add_u32 s7, s6, 29696
    buffer_load_dwordx4 v[180:183], v4, s[48:51], s7 offen
    s_add_u32 s7, s6, 30720
    buffer_load_dwordx4 v[184:187], v4, s[48:51], s7 offen
    s_add_u32 s7, s6, 31744
    buffer_load_dwordx4 v[188:191], v4, s[48:51], s7 offen
    s_add_u32 s7, s6, 0
    buffer_load_dwordx4 v[64:67], v4, s[48:51], s7 offen
    s_add_u32 s7, s6, 1024
    buffer_load_dwordx4 v[68:71], v4, s[48:51], s7 offen
    s_add_u32 s7, s6, 2048
    buffer_load_dwordx4 v[72:75], v4, s[48:51], s7 offen
    s_add_u32 s7, s6, 3072
    buffer_load_dwordx4 v[76:79], v4, s[48:51], s7 offen
    s_add_u32 s7, s6, 4096
    buffer_load_dwordx4 v[80:83], v4, s[48:51], s7 offen
    s_add_u32 s7, s6, 5120
    buffer_load_dwordx4 v[84:87], v4, s[48:51], s7 offen
    s_add_u32 s7, s6, 6144
    buffer_load_dwordx4 v[88:91], v4, s[48:51], s7 offen
    s_add_u32 s7, s6, 7168
    buffer_load_dwordx4 v[92:95], v4, s[48:51], s7 offen
    s_add_u32 s7, s6, 8192
    buffer_load_dwordx4 v[96:99], v4, s[48:51], s7 offen
    s_add_u32 s7, s6, 9216
    buffer_load_dwordx4 v[100:103], v4, s[48:51], s7 offen
    s_add_u32 s7, s6, 10240
    buffer_load_dwordx4 v[104:107], v4, s[48:51], s7 offen
    s_add_u32 s7, s6, 11264
    buffer_load_dwordx4 v[108:111], v4, s[48:51], s7 offen
    s_add_u32 s7, s6, 12288
    buffer_load_dwordx4 v[112:115], v4, s[48:51], s7 offen
    s_add_u32 s7, s6, 13312
    buffer_load_dwordx4 v[116:119], v4, s[48:51], s7 offen
    s_add_u32 s7, s6, 14336
    buffer_load_dwordx4 v[120:123], v4, s[48:51], s7 offen
    s_add_u32 s7, s6, 15360
    buffer_load_dwordx4 v[124:127], v4, s[48:51], s7 offen
    s_add_u32 s7, s6, 16384
    buffer_load_dwordx4 v[128:131], v4, s[48:51], s7 offen
    s_add_u32 s7, s6, 17408
    buffer_load_dwordx4 v[132:135], v4, s[48:51], s7 offen
    s_add_u32 s7, s6, 18432
    buffer_load_dwordx4 v[136:139], v4, s[48:51], s7 offen
    s_add_u32 s7, s6, 19456
    buffer_load_dwordx4 v[140:143], v4, s[48:51], s7 offen
    s_add_u32 s7, s6, 20480
    buffer_load_dwordx4 v[144:147], v4, s[48:51], s7 offen
    s_add_u32 s7, s6, 21504
    buffer_load_dwordx4 v[148:151], v4, s[48:51], s7 offen
    s_add_u32 s7, s6, 22528
    buffer_load_dwordx4 v[152:155], v4, s[48:51], s7 offen
    s_add_u32 s7, s6, 23552
    buffer_load_dwordx4 v[156:159], v4, s[48:51], s7 offen
    s_add_u32 s7, s6, 24576
    buffer_load_dwordx4 v[160:163], v4, s[48:51], s7 offen
    s_add_u32 s7, s6, 25600
    buffer_load_dwordx4 v[164:167], v4, s[48:51], s7 offen
    s_add_u32 s7, s6, 26624
    buffer_load_dwordx4 v[168:171], v4, s[48:51], s7 offen
    s_add_u32 s7, s6, 27648
    buffer_load_dwordx4 v[172:175], v4, s[48:51], s7 offen
    s_branch LL_wodb
LL_wodb:
    s_mov_b32 s44, s24
    s_and_b32 s45, s25, 0xffff
    s_mov_b32 s46, 0x400000
    s_mov_b32 s47, 0x00020000
    s_lshl_b32 s6, s68, 8
    s_lshl_b32 s7, s69, 19
    s_add_u32 s6, s6, s7
    s_lshl_b32 s7, s3, 15
    s_add_u32 s6, s6, s7
    buffer_load_dwordx4 v[192:195], v6, s[44:47], s6 offen
    s_add_u32 s6, s6, 131072
    buffer_load_dwordx4 v[196:199], v6, s[44:47], s6 offen
    s_add_u32 s6, s6, 131072
    buffer_load_dwordx4 v[200:203], v6, s[44:47], s6 offen
    s_add_u32 s6, s6, 131072
    buffer_load_dwordx4 v[204:207], v6, s[44:47], s6 offen
    s_add_u32 s6, s6, 131072
    s_waitcnt vmcnt(0)
LW11:
    s_sleep 2
    ds_read_b32 v252, v250 offset:12
    s_waitcnt lgkmcnt(0)
    v_readfirstlane_b32 s79, v252
    s_cmp_lt_u32 s79, 4
    s_cbranch_scc1 LW11
    s_lshl_b32 s8, s3, 10
    s_add_u32 s8, s8, 135168
    v_add_u32 v7, s8, v4
    ds_write_b128 v7, v[192:195] offset:0
    ds_write_b128 v7, v[196:199] offset:4096
    ds_write_b128 v7, v[200:203] offset:8192
    ds_write_b128 v7, v[204:207] offset:12288
LW12:
    s_sleep 2
    ds_read_b32 v252, v250 offset:44
    s_waitcnt lgkmcnt(0)
    v_readfirstlane_b32 s79, v252
    s_cmp_lt_u32 s79, 4
    s_cbranch_scc1 LW12
    s_mul_i32 s8, s3, 33792
    v_add_u32 v7, s8, v4
    ds_write_b128 v7, v[64:67] offset:0
    ds_write_b128 v7, v[68:71] offset:1056
    ds_write_b128 v7, v[72:75] offset:2112
    ds_write_b128 v7, v[76:79] offset:3168
    ds_write_b128 v7, v[80:83] offset:4224
    ds_write_b128 v7, v[84:87] offset:5280
    ds_write_b128 v7, v[88:91] offset:6336
    ds_write_b128 v7, v[92:95] offset:7392
    ds_write_b128 v7, v[96:99] offset:8448
    ds_write_b128 v7, v[100:103] offset:9504
    ds_write_b128 v7, v[104:107] offset:10560
    ds_write_b128 v7, v[108:111] offset:11616
    ds_write_b128 v7, v[112:115] offset:12672
    ds_write_b128 v7, v[116:119] offset:13728
    ds_write_b128 v7, v[120:123] offset:14784
    ds_write_b128 v7, v[124:127] offset:15840
    ds_write_b128 v7, v[128:131] offset:16896
    ds_write_b128 v7, v[132:135] offset:17952
    ds_write_b128 v7, v[136:139] offset:19008
    ds_write_b128 v7, v[140:143] offset:20064
    ds_write_b128 v7, v[144:147] offset:21120
    ds_write_b128 v7, v[148:151] offset:22176
    ds_write_b128 v7, v[152:155] offset:23232
    ds_write_b128 v7, v[156:159] offset:24288
    ds_write_b128 v7, v[160:163] offset:25344
    ds_write_b128 v7, v[164:167] offset:26400
    ds_write_b128 v7, v[168:171] offset:27456
    ds_write_b128 v7, v[172:175] offset:28512
    ds_write_b128 v7, v[176:179] offset:29568
    ds_write_b128 v7, v[180:183] offset:30624
    ds_write_b128 v7, v[184:187] offset:31680
    ds_write_b128 v7, v[188:191] offset:32736
    s_waitcnt lgkmcnt(0)
    s_mov_b64 exec, 1
    ds_add_u32 v250, v251 offset:24
    s_mov_b64 exec, -1
L_done:
    s_endpgm
.section .rodata,"a"
.p2align 6
.amdhsa_kernel k0_kernel
  .amdhsa_next_free_vgpr 136
  .amdhsa_next_free_sgpr 102
  .amdhsa_accum_offset 136
  .amdhsa_group_segment_fixed_size 0
  .amdhsa_kernarg_size 112
  .amdhsa_user_sgpr_count 2
  .amdhsa_user_sgpr_kernarg_segment_ptr 1
  .amdhsa_system_sgpr_workgroup_id_x 1
  .amdhsa_float_denorm_mode_32 3
.end_amdhsa_kernel
.p2align 6
.amdhsa_kernel k1_kernel
  .amdhsa_next_free_vgpr 256
  .amdhsa_next_free_sgpr 102
  .amdhsa_accum_offset 256
  .amdhsa_group_segment_fixed_size 0
  .amdhsa_kernarg_size 112
  .amdhsa_user_sgpr_count 2
  .amdhsa_user_sgpr_kernarg_segment_ptr 1
  .amdhsa_system_sgpr_workgroup_id_x 1
  .amdhsa_float_denorm_mode_32 3
.end_amdhsa_kernel
```
